```python
import torch

def _softmax(x, axis=-1):
    return torch.softmax(x, dim=axis)
def _gelu(x):
    return torch.nn.functional.gelu(x, approximate="tanh")
def _silu(x):
    return torch.nn.functional.silu(x)
def _sigmoid(x):
    return torch.sigmoid(x)
def _layernorm(x, axis=-1, eps=1e-5):
    m = x.mean(dim=axis, keepdim=True)
    v = x.var(dim=axis, keepdim=True, unbiased=False)
    return (x - m) / torch.sqrt(v + eps)
def _scatter_add(tgt, idx, src, axis=0):
    return tgt.clone().index_add_(axis, idx, src)
def _segment_sum(src, seg, n):
    out = torch.zeros((n,) + src.shape[1:], dtype=src.dtype)
    return out.index_add_(0, seg, src)
def _pad(x, pw):
    flat = tuple(v for pair in reversed(pw) for v in pair)
    return torch.nn.functional.pad(x, flat)

kernel_name = 'interleave_layers__sliding_block_cached__dense_activation_mish__decode'

def setup_inputs():

    _w = (lambda a: (lambda t: t.to(torch.bfloat16) if t.is_floating_point() else t)(torch.as_tensor(a)))
    def _A_setup():
        B, Sq, D = 1, 1, 512
        Hq, Hkv, Sk, Dh = 32, 8, 65536, 128
        assert Hq % Hkv == 0, (Hq, Hkv)
        return {
            "x": _w((lambda *s: torch.randn(*s, dtype=torch.bfloat16) * 0.05)(B, Sq, D)),
            "k_cache": _w((lambda *s: torch.randn(*s, dtype=torch.bfloat16) * 0.8)(B, Hkv, Sk, Dh)),
            "v_cache": _w((lambda *s: torch.randn(*s, dtype=torch.bfloat16) * 1.6)(B, Hkv, Sk, Dh)),
            "wq": _w((lambda *s: torch.randn(*s, dtype=torch.bfloat16) * 0.8)(D, Hq * Dh) * (D ** -0.5)),
            "wo": _w((lambda *s: torch.randn(*s, dtype=torch.bfloat16) * 1.6)(Hq * Dh, D) * ((Hq * Dh) ** -0.5)),
        }
    _A_in = _A_setup()

    def _B_setup():
        B, S, D, F = 1, 1, 512, 1792
        return {
            "x": _w((lambda *s: torch.randn(*s, dtype=torch.bfloat16) * 0.05)(B, S, D)),
            "w1": _w((lambda *s: torch.randn(*s, dtype=torch.bfloat16) * 1.6)(D, F) * (D ** -0.5)),
            "b1": _w((lambda *s: torch.randn(*s, dtype=torch.bfloat16) * 0.4)(F)),
            "w2": _w((lambda *s: torch.randn(*s, dtype=torch.bfloat16) * 0.2)(F, D) * (F ** -0.5)),
        }
    _B_in = _B_setup()

    return {
        "A_x": _A_in["x"],
        "A_k_cache": _A_in["k_cache"],
        "A_v_cache": _A_in["v_cache"],
        "A_wq": _A_in["wq"],
        "A_wo": _A_in["wo"],
        "B_x": _B_in["x"],
        "B_w1": _B_in["w1"],
        "B_b1": _B_in["b1"],
        "B_w2": _B_in["w2"],
    }

def reference(A_x, A_k_cache, A_v_cache, A_wq, A_wo, B_x, B_w1, B_b1, B_w2):
    def _A_ref(x, k_cache, v_cache, wq, wo):
        B, Sq, D = x.shape
        Hq, Dh = 32, 128
        Hkv, Sk = k_cache.shape[1], k_cache.shape[2]
        W = min(4096, max(256, Sk // 4))
        rep = Hq // Hkv
        q = (lambda x, *d: x.permute(*d))((x @ wq).reshape(B, Sq, Hq, Dh), 0, 2, 1, 3)
        k = (lambda x, n, axis: torch.repeat_interleave(x, n, dim=axis))(k_cache[:, :, Sk - W:, :], rep, axis=1)
        v = (lambda x, n, axis: torch.repeat_interleave(x, n, dim=axis))(v_cache[:, :, Sk - W:, :], rep, axis=1)
        scores = torch.einsum("bhqd,bhkd->bhqk", q, k) * (Dh ** -0.5)
        p = _softmax(scores, axis=-1)
        o = torch.einsum("bhqk,bhkd->bhqd", p, v)
        return (lambda x, *d: x.permute(*d))(o, 0, 2, 1, 3).reshape(B, Sq, Hq * Dh) @ wo

    def _B_ref(x, w1, b1, w2):
        h = torch.einsum("bsd,df->bsf", x, w1) + b1
        sp = torch.log1p(torch.exp(-torch.abs(h))) + torch.where(h > 0, h, torch.zeros_like(h))
        act = h * torch.tanh(sp)
        return torch.einsum("bsf,fd->bsd", act, w2)

    x = A_x
    x = x + _A_ref(_layernorm(x, axis=-1), A_k_cache, A_v_cache, A_wq, A_wo)
    x = x + _B_ref(_layernorm(x, axis=-1), B_w1, B_b1, B_w2)
    x = x + _A_ref(_layernorm(x, axis=-1), A_k_cache, A_v_cache, A_wq, A_wo)
    x = x + _B_ref(_layernorm(x, axis=-1), B_w1, B_b1, B_w2)
    return x
```

```asm
; @launch grid=(256,1,1) block=(320,1,1) lds=92160
.amdgcn_target "amdgcn-amd-amdhsa--gfx950"
.text
.globl interleave_layers__sliding_block_cached__dense_activation_mish__decode_kernel
.p2align 8
.type interleave_layers__sliding_block_cached__dense_activation_mish__decode_kernel,@function
interleave_layers__sliding_block_cached__dense_activation_mish__decode_kernel:
L_start:
    s_cmp_ge_u32 s2, 256
    s_cbranch_scc1 L_end
    s_load_dwordx16 s[68:83], s[0:1], 0
    s_load_dwordx8 s[84:91], s[0:1], 64
    s_getpc_b64 s[44:45]
L_pc:
    s_sub_u32 s44, s44, L_pc-L_start
    s_subb_u32 s45, s45, 0
    s_mov_b32 s46, L_codeend-L_start
    s_mov_b32 s47, 0x20000
    s_lshr_b32 s3, s2, 3
    s_mul_i32 s3, s3, 640
    v_lshl_add_u32 v169, v0, 7, s3
    v_cmp_lt_u32 vcc, 4, v0
    s_nop 1
    v_cndmask_b32 v169, v169, -1, vcc
    buffer_load_dword v169, v169, s[44:47], 0 offen
    v_lshrrev_b32 v6, 6, v0
    v_and_b32 v1, 63, v0
    s_and_b32 s4, s2, 7
    s_lshr_b32 s5, s2, 3
    v_readfirstlane_b32 s6, v6
    s_and_b32 s49, s5, 15
    s_lshr_b32 s7, s49, 2
    s_lshr_b32 s50, s5, 4
    s_and_b32 s48, s5, 3
    s_lshl_b32 s3, s50, 2
    s_or_b32 s48, s48, s3
    v_and_b32 v2, 15, v1
    v_lshrrev_b32 v3, 4, v1
    s_mov_b32 s54, 0
    s_cmp_eq_u32 s6, 4
    s_cbranch_scc1 L_loader
    s_lshl_b32 s3, s7, 20
    s_lshl_b32 s92, s4, 10
    s_add_u32 s3, s3, s92
    s_lshl_b32 s92, s48, 7
    s_add_u32 s64, s3, s92
    s_and_b32 s3, s5, 31
    s_lshl_b32 s3, s3, 10
    s_add_u32 s3, s3, 15728640
    s_lshl_b32 s92, s4, 24
    s_add_u32 s65, s3, s92
    v_lshrrev_b32 v162, 3, v1
    v_lshlrev_b32 v162, 13, v162
    v_and_b32 v6, 7, v1
    v_lshl_add_u32 v162, v6, 4, v162
    v_and_b32 v167, 1, v3
    v_lshlrev_b32 v167, 5, v167
    v_xor_b32 v162, v167, v162
    s_and_b32 s3, s6, 1
    s_lshl_b32 s3, s3, 6
    v_xor_b32 v162, s3, v162
    v_lshlrev_b32 v167, 4, v0
    s_lshl_b32 s3, s7, 8
    v_lshl_add_u32 v168, v1, 2, s3
    s_lshl_b32 s3, s6, 10
    v_add_u32 v168, s3, v168
    v_lshrrev_b32 v185, 5, v1
    v_lshl_add_u32 v7, v2, 1, v185
    s_lshl_b32 s66, s49, 6
    s_add_u32 s3, s3, s66
    v_lshl_add_u32 v170, v7, 1, s3
    v_xor_b32 v163, v2, v3
    v_lshlrev_b32 v163, 4, v163
    v_lshl_add_u32 v163, v3, 8, v163
    v_xor_b32 v164, 64, v163
    v_xor_b32 v165, 128, v163
    v_xor_b32 v166, 192, v163
    s_lshl_b32 s92, s6, 18
    s_lshl_b32 s93, s6, 12
    s_mov_b32 s10, 1024
    s_mov_b32 s11, 0x20000
    s_mov_b32 s22, 1040512
    s_mov_b32 s23, 0x20000
    s_mov_b32 s14, 1016832
    s_mov_b32 s15, 0x20000
    s_mov_b32 s38, 2097152
    s_mov_b32 s39, 0x20000
    s_lshl_b32 s3, s4, 13
    s_lshl_b32 s66, s7, 11
    s_add_u32 s3, s3, s66
    s_lshl_b32 s66, s48, 8
    s_add_u32 s3, s3, s66
    s_add_u32 s3, s3, 65536
    v_lshl_add_u32 v171, v0, 7, s3
    v_cmp_lt_u32 vcc, 1, v0
    s_nop 1
    v_cndmask_b32 v171, v171, -1, vcc
    s_waitcnt lgkmcnt(0)
    s_mov_b32 s8, s68
    s_mov_b32 s9, s69
    s_add_u32 s20, s74, s64
    s_addc_u32 s21, s75, 0
    s_add_u32 s12, s70, s65
    s_addc_u32 s13, s71, 0
    s_add_u32 s16, s72, s65
    s_addc_u32 s17, s73, 0
    s_load_dword s57, s[90:91], 0
    buffer_load_dwordx4 v[150:153], v167, s[8:11], 0 offen
    buffer_load_dword v154, v168, s[8:11], 0 offen
    buffer_load_ushort v144, v170, s[8:11], 0 offen
    s_mov_b32 s36, s90
    s_mov_b32 s37, s91
    s_add_u32 m0, s93, 0
    s_nop 0
    buffer_load_dwordx4 v162, s[20:23], s92 offen nt lds
    s_add_u32 s92, s92, 0x10000
    buffer_load_dword v149, v171, s[36:39], 0 offen
    s_add_u32 m0, s93, 1024
    s_nop 0
    buffer_load_dwordx4 v162, s[20:23], s92 offen nt lds
    s_add_u32 s92, s92, 0x10000
    s_add_u32 m0, s93, 2048
    s_nop 0
    buffer_load_dwordx4 v162, s[20:23], s92 offen nt lds
    s_add_u32 s92, s92, 0x10000
    s_add_u32 m0, s93, 3072
    s_nop 0
    buffer_load_dwordx4 v162, s[20:23], s92 offen nt lds
    s_lshl_b32 s92, s6, 13
    s_barrier
    v_mov_b32 v64, v163
    v_mov_b32 v65, v164
    v_mov_b32 v66, v165
    v_mov_b32 v67, v166
    s_lshl_b32 s64, s6, 13
    s_lshl_b32 s65, s6, 18
    s_add_u32 m0, s64, 16384
    s_nop 0
    buffer_load_dwordx4 v64, s[12:15], s65 offen nt lds
    s_add_u32 s65, s65, 0x8000
    s_add_u32 m0, s64, 17408
    s_nop 0
    buffer_load_dwordx4 v65, s[12:15], s65 offen nt lds
    s_add_u32 s65, s65, 0x8000
    s_mov_b32 s18, 1016832
    s_mov_b32 s19, 0x20000
    v_lshl_add_u32 v5, v6, 2, v3
    s_movk_i32 s52, 0xff
    s_mov_b32 s60, 0xffff0000
    s_getreg_b32 s56, hwreg(HW_REG_XCC_ID)
    s_mov_b32 s63, 65536
    s_mov_b32 s67, 131072
    v_and_b32 v184, 31, v1
    v_lshrrev_b32 v188, 2, v2
    v_and_b32 v189, 3, v2
    v_lshl_add_u32 v182, v3, 5, v188
    v_lshlrev_b32 v182, 7, v182
    v_lshl_add_u32 v182, v189, 3, v182
    s_lshl_b32 s3, s6, 5
    v_add_u32 v182, s3, v182
    v_and_b32 v183, 8, v2
    v_lshlrev_b32 v183, 2, v183
    v_xor_b32 v182, v183, v182
    v_and_b32 v183, 1, v3
    v_lshlrev_b32 v183, 6, v183
    v_xor_b32 v182, v183, v182
    s_mov_b32 s3, 81920
    v_lshl_add_u32 v183, v3, 6, s3
    s_cmp_eq_u32 s6, 0
    s_cselect_b32 s3, s3, 83712
    v_lshl_add_u32 v181, v1, 2, s3
    v_lshlrev_b32 v179, 4, v1
    v_mov_b32 v136, 0x3f803f80
    v_mov_b32 v137, 0x3f803f80
    v_mov_b32 v138, 0x3f803f80
    v_mov_b32 v139, 0x3f803f80
    s_mov_b32 s88, 65536
    s_lshl_b32 s3, s4, 13
    s_add_u32 s88, s88, s3
    s_lshl_b32 s3, s7, 11
    s_add_u32 s88, s88, s3
    s_lshl_b32 s3, s48, 8
    s_add_u32 s88, s88, s3
    s_lshl_b32 s3, s6, 6
    s_add_u32 s88, s88, s3
    v_lshl_add_u32 v9, v2, 2, s88
    s_mov_b32 s88, 65536
    s_lshl_b32 s3, s4, 13
    s_add_u32 s88, s88, s3
    s_lshl_b32 s3, s6, 9
    s_add_u32 s88, s88, s3
    v_lshl_add_u32 v10, v185, 12, s88
    v_lshl_add_u32 v10, v184, 4, v10
    s_mov_b32 s88, 4096
    s_lshl_b32 s3, s4, 9
    s_add_u32 s88, s88, s3
    v_lshl_add_u32 v178, v184, 4, s88
    s_mov_b32 s88, 4096
    s_lshl_b32 s3, s4, 9
    s_add_u32 s88, s88, s3
    s_lshl_b32 s3, s5, 4
    s_add_u32 s88, s88, s3
    s_lshl_b32 s3, s6, 28
    s_add_u32 s88, s88, s3
    v_mov_b32 v180, s88
    s_waitcnt vmcnt(7)
    v_lshlrev_b32 v162, 16, v150
    v_and_b32 v163, s60, v150
    v_lshlrev_b32 v164, 16, v151
    v_and_b32 v165, s60, v151
    v_lshlrev_b32 v166, 16, v152
    v_and_b32 v167, s60, v152
    v_lshlrev_b32 v168, 16, v153
    v_and_b32 v169, s60, v153
    v_add_f32 v170, v162, v163
    v_mul_f32 v171, v162, v162
    v_fmac_f32 v171, v163, v163
    v_add_f32 v170, v170, v164
    v_fmac_f32 v171, v164, v164
    v_add_f32 v170, v170, v165
    v_fmac_f32 v171, v165, v165
    v_add_f32 v170, v170, v166
    v_fmac_f32 v171, v166, v166
    v_add_f32 v170, v170, v167
    v_fmac_f32 v171, v167, v167
    v_add_f32 v170, v170, v168
    v_fmac_f32 v171, v168, v168
    v_add_f32 v170, v170, v169
    v_fmac_f32 v171, v169, v169
    v_mov_b32 v172, v170
    v_mov_b32 v173, v171
    v_lshlrev_b32 v162, 16, v154
    v_permlane16_swap_b32 v172, v170
    v_permlane16_swap_b32 v173, v171
    v_add_f32 v170, v170, v172
    v_add_f32 v171, v171, v173
    v_mov_b32 v172, v170
    v_mov_b32 v173, v171
    v_and_b32 v163, s60, v154
    v_permlane32_swap_b32 v172, v170
    v_permlane32_swap_b32 v173, v171
    v_add_f32 v170, v170, v172
    v_add_f32 v171, v171, v173
    s_nop 0
    v_add_f32_dpp v170, v170, v170 row_ror:8 row_mask:0xf bank_mask:0xf
    v_add_f32_dpp v171, v171, v171 row_ror:8 row_mask:0xf bank_mask:0xf
    s_nop 0
    v_add_f32_dpp v170, v170, v170 row_ror:4 row_mask:0xf bank_mask:0xf
    v_add_f32_dpp v171, v171, v171 row_ror:4 row_mask:0xf bank_mask:0xf
    s_nop 0
    v_add_f32_dpp v170, v170, v170 row_ror:2 row_mask:0xf bank_mask:0xf
    v_add_f32_dpp v171, v171, v171 row_ror:2 row_mask:0xf bank_mask:0xf
    s_nop 0
    v_add_f32_dpp v170, v170, v170 row_ror:1 row_mask:0xf bank_mask:0xf
    v_add_f32_dpp v171, v171, v171 row_ror:1 row_mask:0xf bank_mask:0xf
    v_mul_f32 v170, 0x3b000000, v170
    v_mul_f32 v171, 0x3b000000, v171
    v_fma_f32 v171, -v170, v170, v171
    v_max_f32 v171, 0, v171
    v_cvt_pk_bf16_f32 v172, v170, v171
    v_and_b32 v171, s60, v172
    v_lshlrev_b32 v147, 16, v172
    v_add_f32 v171, 0x3727c5ac, v171
    v_cvt_pk_bf16_f32 v171, v171, v171
    v_and_b32 v171, s60, v171
    v_sqrt_f32 v171, v171
    s_nop 0
    v_cvt_pk_bf16_f32 v171, v171, v171
    v_and_b32 v171, s60, v171
    v_rcp_f32 v148, v171
    v_sub_f32 v162, v162, v147
    v_sub_f32 v163, v163, v147
    v_cvt_pk_bf16_f32 v163, v162, v163
    v_lshlrev_b32 v162, 16, v163
    v_and_b32 v163, s60, v163
    v_mul_f32 v162, v162, v148
    v_mul_f32 v163, v163, v148
    v_cvt_pk_bf16_f32 v162, v162, v163
    ds_write_b32 v181, v162
    v_mov_b32 v147, 0
    v_mov_b32 v148, 1.0
    s_waitcnt lgkmcnt(0)
    s_add_u32 s51, s57, 1
    s_and_b32 s51, s51, 0xff
    v_mov_b32 v4, s51
    s_and_b32 s56, s56, 0xff
    s_lshl_b32 s56, s56, 8
    s_or_b32 s56, s56, s51
    v_mov_b32 v166, s56
    v_mov_b32 v167, s56
    v_mov_b32 v168, s56
    v_mov_b32 v169, s56
    s_mov_b64 exec, 1
    buffer_store_dwordx4 v[166:169], v180, s[36:39], 0 offen sc1
    s_mov_b64 exec, -1
    s_lshl_b32 s92, s6, 18
    s_waitcnt vmcnt(3)
    s_add_u32 m0, s64, 18432
    s_nop 0
    buffer_load_dwordx4 v66, s[12:15], s65 offen nt lds
    s_add_u32 s65, s65, 0x8000
    s_add_u32 m0, s64, 19456
    s_nop 0
    buffer_load_dwordx4 v67, s[12:15], s65 offen nt lds
    s_add_u32 s65, s65, 0x8000
    s_barrier
    ds_read2_b64 v[162:165], v183 offset0:0 offset1:4
    ds_read_b64_tr_b16 a[32:33], v182 offset:0
    ds_read_b64_tr_b16 a[34:35], v182 offset:2048
    ds_read2_b64 v[166:169], v183 offset0:1 offset1:5
    ds_read_b64_tr_b16 a[36:37], v182 offset:512
    ds_read_b64_tr_b16 a[38:39], v182 offset:2560
    ds_read2_b64 v[170:173], v183 offset0:2 offset1:6
    ds_read_b64_tr_b16 a[40:41], v182 offset:1024
    ds_read_b64_tr_b16 a[42:43], v182 offset:3072
    ds_read2_b64 v[174:177], v183 offset0:3 offset1:7
    ds_read_b64_tr_b16 a[44:45], v182 offset:1536
    ds_read_b64_tr_b16 a[46:47], v182 offset:3584
    s_waitcnt lgkmcnt(9)
    v_mfma_f32_16x16x32_bf16 v[68:71], v[162:165], a[32:35], 0
    s_waitcnt lgkmcnt(6)
    v_mfma_f32_16x16x32_bf16 v[68:71], v[166:169], a[36:39], v[68:71]
    s_waitcnt lgkmcnt(3)
    v_mfma_f32_16x16x32_bf16 v[68:71], v[170:173], a[40:43], v[68:71]
    s_waitcnt lgkmcnt(0)
    v_mfma_f32_16x16x32_bf16 v[68:71], v[174:177], a[44:47], v[68:71]
    s_mov_b64 exec, 0xffff
    s_nop 6
    v_bfi_b32 v182, s52, v4, v68
    buffer_store_dword v182, v9, s[36:39], 0 offen
    buffer_store_dword v182, v9, s[36:39], s67 offen sc1
    s_mov_b64 exec, -1
    v_mfma_f32_16x16x32_bf16 v[68:71], v[136:139], a[32:35], 0
    v_mfma_f32_16x16x32_bf16 v[68:71], v[136:139], a[36:39], v[68:71]
    v_mfma_f32_16x16x32_bf16 v[68:71], v[136:139], a[40:43], v[68:71]
    v_mfma_f32_16x16x32_bf16 v[68:71], v[136:139], a[44:47], v[68:71]
    s_add_u32 m0, s64, 20480
    s_nop 0
    buffer_load_dwordx4 v64, s[12:15], s65 offen nt lds
    s_add_u32 s65, s65, 0x8000
    s_add_u32 s40, s86, 0
    s_addc_u32 s41, s87, 0
    s_mov_b32 s42, 1024
    s_mov_b32 s43, 0x20000
    s_mov_b32 s53, 0
    s_mov_b32 s55, 400000
    s_add_u32 s98, s90, 1572864
    s_addc_u32 s99, s91, 0
    s_add_u32 s100, s90, 1835008
    s_addc_u32 s101, s91, 0
    s_mov_b32 s58, 0x05040100
    s_mov_b32 s59, 0x07060302
    s_mov_b32 s61, 0x3e0293ee
    s_mov_b32 s62, 0xbfb8aa3b
    s_mov_b32 s66, 0x10000
    s_mov_b32 s67, 139264
    s_mov_b32 s97, 204800
    s_add_u32 m0, s64, 21504
    s_nop 0
    buffer_load_dwordx4 v65, s[12:15], s65 offen nt lds
    s_add_u32 s65, s65, 0x8000
    v_mov_b32 v140, 0
    v_mov_b32 v141, 0
    v_mov_b32 v34, 0
    v_mov_b32 v35, 0
    v_and_b32 v186, 1, v1
    v_lshrrev_b32 v187, 1, v1
    s_mov_b32 s88, 82496
    s_lshl_b32 s3, s6, 8
    s_add_u32 s88, s88, s3
    v_lshl_add_u32 v12, v184, 3, s88
    v_lshl_add_u32 v12, v185, 2, v12
    s_mov_b32 s88, 82496
    v_lshl_add_u32 v13, v188, 8, s88
    v_lshl_add_u32 v13, v3, 4, v13
    s_mov_b32 s88, 83712
    s_lshl_b32 s3, s6, 11
    s_add_u32 s88, s88, s3
    v_lshl_add_u32 v14, v1, 2, s88
    s_add_u32 m0, s64, 22528
    s_nop 0
    buffer_load_dwordx4 v66, s[12:15], s65 offen nt lds
    s_add_u32 s65, s65, 0x8000
    s_mov_b32 s88, 83520
    s_lshl_b32 s3, s6, 2
    s_add_u32 s88, s88, s3
    v_lshl_add_u32 v15, v188, 5, s88
    s_mov_b32 s88, 83536
    s_lshl_b32 s3, s6, 2
    s_add_u32 s88, s88, s3
    v_lshl_add_u32 v16, v3, 5, s88
    s_mov_b32 s88, 83712
    s_lshl_b32 s3, s6, 6
    s_add_u32 s88, s88, s3
    v_lshl_add_u32 v17, v3, 9, s88
    v_lshl_add_u32 v17, v2, 2, v17
    s_mov_b32 s88, 83520
    s_lshl_b32 s3, s6, 5
    s_add_u32 s88, s88, s3
    s_add_u32 m0, s64, 23552
    s_nop 0
    buffer_load_dwordx4 v67, s[12:15], s65 offen nt lds
    s_add_u32 s65, s65, 0x8000
    v_mov_b32 v18, s88
    s_mov_b32 s88, 81920
    v_lshl_add_u32 v8, v3, 4, s88
    s_mov_b32 s88, 8192
    s_lshl_b32 s3, s4, 8
    s_add_u32 s88, s88, s3
    v_lshl_add_u32 v11, v2, 4, s88
    s_mov_b32 s88, 524288
    s_lshl_b32 s3, s4, 16
    s_add_u32 s88, s88, s3
    s_lshl_b32 s3, s6, 14
    s_add_u32 s88, s88, s3
    s_lshl_b32 s3, s5, 7
    s_add_u32 s88, s88, s3
    v_lshl_add_u32 v19, v188, 12, s88
    v_lshl_add_u32 v19, v189, 5, v19
    v_lshl_add_u32 v19, v3, 3, v19
    s_mov_b32 s64, 131072
    s_mov_b32 s65, 131072
    s_mul_i32 s88, s4, 14
    s_add_u32 s88, s88, s49
    s_lshl_b32 s3, s88, 5
    s_add_u32 s32, s82, s3
    s_addc_u32 s33, s83, 0
    s_mov_b32 s35, 0x20000
    s_cmp_lt_u32 s49, 14
    s_cselect_b32 s34, 32, 0
    s_cmp_lg_u32 s50, 0
    s_cselect_b32 s34, s34, 0
    v_lshlrev_b32 v170, 1, v2
    buffer_load_dwordx4 v[36:39], v179, s[16:19], s92 offen nt
    s_add_u32 s92, s92, 0x8000
    s_mov_b32 s88, 32768
    s_lshl_b32 s3, s4, 11
    s_add_u32 s88, s88, s3
    s_lshl_b32 s3, s6, 9
    s_add_u32 s88, s88, s3
    s_lshl_b32 s3, s5, 4
    s_add_u32 s88, s88, s3
    v_mov_b32 v20, s88
    s_mov_b32 s88, 1048576
    s_lshl_b32 s3, s50, 18
    s_add_u32 s88, s88, s3
    s_lshl_b32 s3, s4, 15
    s_add_u32 s88, s88, s3
    s_lshl_b32 s3, s6, 13
    s_add_u32 s88, s88, s3
    s_lshl_b32 s3, s49, 7
    s_add_u32 s88, s88, s3
    v_lshl_add_u32 v21, v3, 11, s88
    v_lshl_add_u32 v21, v2, 3, v21
    buffer_load_dwordx4 v[40:43], v179, s[16:19], s92 offen nt
    s_add_u32 s92, s92, 0x8000
    s_mov_b32 s88, 1048576
    s_lshl_b32 s3, s50, 18
    s_add_u32 s88, s88, s3
    s_lshl_b32 s3, s4, 15
    s_add_u32 s88, s88, s3
    s_lshl_b32 s3, s49, 11
    s_add_u32 s88, s88, s3
    v_lshl_add_u32 v22, v1, 4, s88
    s_mov_b32 s88, 16384
    s_lshl_b32 s3, s4, 11
    s_add_u32 s88, s88, s3
    s_lshl_b32 s3, s7, 9
    s_add_u32 s88, s88, s3
    v_lshl_add_u32 v24, v189, 4, s88
    v_lshl_add_u32 v24, v3, 7, v24
    v_lshrrev_b32 v176, 3, v1
    v_and_b32 v176, 1, v176
    v_and_b32 v175, 1, v5
    v_lshlrev_b32 v175, 4, v175
    v_lshrrev_b32 v174, 1, v5
    v_add_u32 v175, v175, v174
    s_cmp_lg_u32 s50, 0
    s_cselect_b64 vcc, -1, 0
    v_cndmask_b32 v175, v175, v5, vcc
    s_and_b32 s89, s49, 8
    s_add_u32 s89, s89, s49
    buffer_load_dwordx4 v[44:47], v179, s[16:19], s92 offen nt
    s_add_u32 s92, s92, 0x8000
    s_mov_b32 s88, 1572864
    s_lshl_b32 s3, s50, 18
    s_add_u32 s88, s88, s3
    s_lshl_b32 s3, s89, 10
    s_add_u32 s88, s88, s3
    s_lshl_b32 s3, s4, 7
    s_add_u32 s88, s88, s3
    v_lshl_add_u32 v23, v175, 2, s88
    v_lshl_add_u32 v23, v176, 15, v23
    s_mov_b32 s88, 524288
    s_lshl_b32 s3, s4, 16
    s_add_u32 s88, s88, s3
    s_lshl_b32 s3, s49, 12
    s_add_u32 s88, s88, s3
    s_lshl_b32 s3, s6, 5
    s_add_u32 s88, s88, s3
    v_lshl_add_u32 v25, v187, 7, s88
    v_lshl_add_u32 v25, v186, 4, v25
    buffer_load_dwordx4 v[48:51], v179, s[16:19], s92 offen nt
    s_add_u32 s92, s92, 0x8000
    s_mov_b32 s88, 32768
    s_lshl_b32 s3, s4, 11
    s_add_u32 s88, s88, s3
    s_lshl_b32 s3, s7, 9
    s_add_u32 s88, s88, s3
    v_lshl_add_u32 v26, v187, 4, s88
    s_mov_b32 s88, 82432
    s_lshl_b32 s3, s6, 4
    s_add_u32 s88, s88, s3
    v_lshl_add_u32 v27, v186, 3, s88
    v_lshl_add_u32 v27, v3, 1, v27
    s_mov_b32 s88, 8192
    s_lshl_b32 s3, s4, 8
    s_add_u32 s88, s88, s3
    s_lshl_b32 s3, s49, 4
    s_add_u32 s88, s88, s3
    v_lshl_add_u32 v28, v185, 2, s88
    v_lshl_add_u32 v28, v186, 3, v28
    s_lshr_b32 s87, s4, 2
    s_xor_b32 s87, s87, 0
    s_and_b32 s89, s49, 8
    s_add_u32 s89, s89, s49
    buffer_load_ushort v143, v170, s[32:35], 0 offen
    buffer_load_dwordx4 v[158:161], v178, s[36:39], 0 offen sc1
    buffer_load_dwordx4 v[150:153], v10, s[36:39], 0 offen sc1
    buffer_load_dwordx4 v[154:157], v10, s[36:39], 0 offen offset:2048 sc1
    buffer_load_dwordx4 v[52:55], v179, s[16:19], s92 offen nt
    s_add_u32 s92, s92, 0x8000
    s_mov_b32 s88, 0
    s_lshl_b32 s3, s4, 15
    s_add_u32 s88, s88, s3
    s_lshl_b32 s3, s87, 13
    s_add_u32 s88, s88, s3
    s_lshl_b32 s3, s89, 10
    s_add_u32 s88, s88, s3
    v_lshl_add_u32 v29, v1, 3, s88
    s_mov_b32 s88, 16384
    s_lshl_b32 s3, s4, 11
    s_add_u32 s88, s88, s3
    s_lshl_b32 s3, s49, 7
    s_add_u32 s88, s88, s3
    v_lshl_add_u32 v30, v7, 2, s88
    s_mov_b32 s88, 82176
    v_lshl_add_u32 v31, v7, 1, s88
    s_and_b32 s89, s49, 3
    buffer_load_dwordx4 v[56:59], v179, s[16:19], s92 offen nt
    s_add_u32 s92, s92, 0x8000
    s_mov_b32 s88, 262144
    s_lshl_b32 s3, s4, 14
    s_add_u32 s88, s88, s3
    s_lshl_b32 s3, s6, 10
    s_add_u32 s88, s88, s3
    s_lshl_b32 s3, s7, 8
    s_add_u32 s88, s88, s3
    s_lshl_b32 s3, s89, 2
    s_add_u32 s88, s88, s3
    v_lshl_add_u32 v32, v3, 12, s88
    v_lshl_add_u32 v32, v2, 4, v32
    s_mov_b32 s88, 262144
    s_lshl_b32 s3, s4, 14
    s_add_u32 s88, s88, s3
    s_lshl_b32 s3, s49, 10
    s_add_u32 s88, s88, s3
    v_lshl_add_u32 v33, v1, 4, s88
    buffer_load_dwordx4 v[60:63], v179, s[16:19], s92 offen nt
    s_add_u32 s92, s92, 0x8000
    buffer_load_dwordx4 v[64:67], v179, s[16:19], s92 offen nt
    s_add_u32 s92, s92, 0x8000
    v_lshl_add_u32 v181, v189, 2, v188
    v_xor_b32 v180, v181, v3
    v_lshlrev_b32 v180, 4, v180
    v_lshl_add_u32 v180, v181, 8, v180
    s_lshl_b32 s3, s6, 13
    s_add_u32 s3, s3, 16384
    v_add_u32 v180, s3, v180
    v_xor_b32 v181, 64, v180
    v_xor_b32 v182, 128, v180
    v_xor_b32 v183, 192, v180
    s_waitcnt vmcnt(12)
    v_lshlrev_b32 v144, 16, v144
    ds_read_b128 a[0:3], v180 offset:0
    ds_read_b128 a[4:7], v181 offset:0
    ds_read_b128 a[8:11], v182 offset:0
    ds_read_b128 a[12:15], v183 offset:0
    ds_read_b128 a[16:19], v180 offset:4096
    ds_read_b128 a[20:23], v181 offset:4096
    ds_read_b128 a[24:27], v182 offset:4096
    ds_read_b128 a[28:31], v183 offset:4096
    s_mov_b32 s93, 0x42200000
    s_waitcnt vmcnt(4)
    v_bitop3_b32 v188, v150, v151, s51 bitop3:0x7e
    v_bitop3_b32 v189, v152, v153, s51 bitop3:0x7e
    v_bitop3_b32 v190, v154, v155, s51 bitop3:0x7e
    v_bitop3_b32 v191, v156, v157, s51 bitop3:0x7e
    v_add_f32 v162, v150, v154
    v_or3_b32 v188, v188, v189, v190
    v_add_f32 v164, v152, v156
    v_or_b32 v188, v188, v191
    v_add_f32 v163, v151, v155
    v_cmp_ne_u32_sdwa vcc, v188, 0 src0_sel:BYTE_0 src1_sel:DWORD
    v_add_f32 v165, v153, v157
    s_cbranch_vccnz L_p1fail
    s_barrier
L_p1ok:
    v_mov_b32 v186, v68
    s_mov_b64 exec, 0xffff
    v_bfi_b32 v186, s52, v4, v186
    buffer_store_dword v186, v9, s[36:39], s63 offen sc1
    s_mov_b64 exec, -1
L_aft:
    v_permlane32_swap_b32 v162, v164
    v_permlane32_swap_b32 v163, v165
    v_add_f32 v162, v162, v164
    v_add_f32 v163, v163, v165
    v_fma_f32 v162, v162, v148, -v140
    v_fma_f32 v163, v163, v148, -v141
    v_cvt_pk_bf16_f32 v162, v162, v163
    ds_write_b32 v12, v162
    s_waitcnt lgkmcnt(0)
    s_barrier
    ds_read_b128 v[162:165], v13 offset:0
    ds_read_b128 v[166:169], v13 offset:64
    ds_read_b128 v[170:173], v13 offset:128
    ds_read_b128 v[174:177], v13 offset:192
    s_waitcnt lgkmcnt(3)
    v_mfma_f32_16x16x32_bf16 v[178:181], a[0:3], v[162:165], 0
    s_waitcnt lgkmcnt(2)
    v_mfma_f32_16x16x32_bf16 v[178:181], a[4:7], v[166:169], v[178:181]
    v_mfma_f32_16x16x32_bf16 v[182:185], a[16:19], v[162:165], 0
    s_waitcnt lgkmcnt(1)
    v_mfma_f32_16x16x32_bf16 v[178:181], a[8:11], v[170:173], v[178:181]
    v_mfma_f32_16x16x32_bf16 v[182:185], a[20:23], v[166:169], v[182:185]
    s_waitcnt lgkmcnt(0)
    v_mfma_f32_16x16x32_bf16 v[178:181], a[12:15], v[174:177], v[178:181]
    v_mfma_f32_16x16x32_bf16 v[182:185], a[24:27], v[170:173], v[182:185]
    v_mfma_f32_16x16x32_bf16 v[182:185], a[28:31], v[174:177], v[182:185]
    s_nop 5
    v_max3_f32 v186, v178, v179, v180
    v_max_f32 v186, v186, v181
    v_max3_f32 v187, v182, v183, v184
    v_max3_f32 v186, v186, v187, v185
    v_mov_b32 v187, v186
    s_nop 1
    v_permlane16_swap_b32 v187, v186
    v_max_f32 v186, v186, v187
    v_mov_b32 v187, v186
    s_nop 1
    v_permlane32_swap_b32 v187, v186
    v_max_f32 v186, v186, v187
    v_mul_f32 v186, s61, v186
    v_fma_f32 v178, v178, s61, -v186
    v_fma_f32 v179, v179, s61, -v186
    v_fma_f32 v180, v180, s61, -v186
    v_fma_f32 v181, v181, s61, -v186
    v_fma_f32 v182, v182, s61, -v186
    v_fma_f32 v183, v183, s61, -v186
    v_fma_f32 v184, v184, s61, -v186
    v_fma_f32 v185, v185, s61, -v186
    ds_write_b32 v15, v186
    v_exp_f32 v178, v178
    v_exp_f32 v179, v179
    v_exp_f32 v180, v180
    v_exp_f32 v181, v181
    v_exp_f32 v182, v182
    v_exp_f32 v183, v183
    v_exp_f32 v184, v184
    v_exp_f32 v185, v185
    v_cvt_pk_bf16_f32 v162, v178, v179
    v_cvt_pk_bf16_f32 v163, v180, v181
    v_cvt_pk_bf16_f32 v164, v182, v183
    v_cvt_pk_bf16_f32 v165, v184, v185
    s_cmp_lg_u32 s54, 0
    s_cbranch_scc1 L_a1
    v_bitop3_b32 v188, v158, v159, s51 bitop3:0x7e
    v_bitop3_b32 v189, v160, v161, s51 bitop3:0x7e
    v_or_b32 v188, v188, v189
    v_cmp_ne_u32_sdwa vcc, v188, 0 src0_sel:BYTE_0 src1_sel:DWORD
    s_cbranch_vccz L_xcok
    v_and_b32 v179, 31, v1
    s_mov_b32 s88, 4096
    s_lshl_b32 s3, s4, 9
    s_add_u32 s88, s88, s3
    v_lshl_add_u32 v178, v179, 4, s88
L_poll_1:
    buffer_load_dwordx4 v[158:161], v178, s[36:39], 0 offen sc1
    s_sub_u32 s55, s55, 1
    s_cbranch_scc1 L_bail
    s_waitcnt vmcnt(0)
    v_bitop3_b32 v188, v158, v159, s51 bitop3:0x7e
    v_bitop3_b32 v189, v160, v161, s51 bitop3:0x7e
    v_or_b32 v188, v188, v189
    v_cmp_ne_u32_sdwa vcc, v188, 0 src0_sel:BYTE_0 src1_sel:DWORD
    s_cbranch_vccnz L_poll_1
L_xcok:
    v_cmp_ne_u32 vcc, s56, v158
    s_cmp_eq_u64 vcc, 0
    s_cselect_b32 s53, 1, 0
    v_perm_b32 v72, v40, v36, s58
    v_perm_b32 v73, v48, v44, s58
    v_perm_b32 v76, v40, v36, s59
    v_perm_b32 v77, v48, v44, s59
    v_perm_b32 v80, v41, v37, s58
    v_perm_b32 v81, v49, v45, s58
    v_perm_b32 v84, v41, v37, s59
    v_perm_b32 v85, v49, v45, s59
    v_perm_b32 v88, v42, v38, s58
    v_perm_b32 v89, v50, v46, s58
    v_perm_b32 v92, v42, v38, s59
    v_perm_b32 v93, v50, v46, s59
    v_perm_b32 v96, v43, v39, s58
    v_perm_b32 v97, v51, v47, s58
    v_perm_b32 v100, v43, v39, s59
    v_perm_b32 v101, v51, v47, s59
    s_waitcnt vmcnt(1)
    v_perm_b32 v74, v56, v52, s58
    v_perm_b32 v75, v64, v60, s58
    v_perm_b32 v78, v56, v52, s59
    v_perm_b32 v79, v64, v60, s59
    v_perm_b32 v82, v57, v53, s58
    v_perm_b32 v83, v65, v61, s58
    v_perm_b32 v86, v57, v53, s59
    v_perm_b32 v87, v65, v61, s59
    v_perm_b32 v90, v58, v54, s58
    v_perm_b32 v91, v66, v62, s58
    v_perm_b32 v94, v58, v54, s59
    v_perm_b32 v95, v66, v62, s59
    v_perm_b32 v98, v59, v55, s58
    v_perm_b32 v99, v67, v63, s58
    v_perm_b32 v102, v59, v55, s59
    v_perm_b32 v103, v67, v63, s59
L_a1:
    v_mfma_f32_16x16x32_bf16 v[68:71], v[162:165], v[136:139], 0
    v_mfma_f32_16x16x32_bf16 v[36:39], v[162:165], v[72:75], 0
    v_mfma_f32_16x16x32_bf16 v[40:43], v[162:165], v[76:79], 0
    v_mfma_f32_16x16x32_bf16 v[44:47], v[162:165], v[80:83], 0
    v_mfma_f32_16x16x32_bf16 v[48:51], v[162:165], v[84:87], 0
    v_mfma_f32_16x16x32_bf16 v[52:55], v[162:165], v[88:91], 0
    s_nop 2
    ds_write_b32 v16, v68
    v_mfma_f32_16x16x32_bf16 v[56:59], v[162:165], v[92:95], 0
    s_nop 1
    ds_write2st64_b32 v14, v36, v40 offset0:0 offset1:1
    v_mfma_f32_16x16x32_bf16 v[60:63], v[162:165], v[96:99], 0
    v_mfma_f32_16x16x32_bf16 v[64:67], v[162:165], v[100:103], 0
    s_nop 1
    ds_write2st64_b32 v14, v44, v48 offset0:2 offset1:3
    ds_write2st64_b32 v14, v52, v56 offset0:4 offset1:5
    s_nop 3
    ds_write2st64_b32 v14, v60, v64 offset0:6 offset1:7
    s_waitcnt lgkmcnt(0)
    s_barrier
    ds_read_b128 v[162:165], v18
    ds_read_b128 v[166:169], v18 offset:16
    ds_read2st64_b32 v[170:171], v17 offset0:0 offset1:1
    ds_read2st64_b32 v[172:173], v17 offset0:8 offset1:9
    ds_read2st64_b32 v[174:175], v17 offset0:16 offset1:17
    ds_read2st64_b32 v[176:177], v17 offset0:24 offset1:25
    s_waitcnt lgkmcnt(5)
    v_max3_f32 v178, v162, v163, v164
    v_max_f32 v178, v178, v165
    v_bfi_b32 v178, s52, v4, v178
    v_sub_f32 v162, v162, v178
    v_sub_f32 v163, v163, v178
    v_sub_f32 v164, v164, v178
    v_sub_f32 v165, v165, v178
    v_exp_f32 v162, v162
    v_exp_f32 v163, v163
    v_exp_f32 v164, v164
    v_exp_f32 v165, v165
    s_cmp_eq_u32 s53, 0
    s_waitcnt lgkmcnt(0)
    v_mul_f32 v182, v162, v170
    v_mul_f32 v183, v162, v171
    v_fmac_f32 v182, v163, v172
    v_fmac_f32 v183, v163, v173
    v_fmac_f32 v182, v164, v174
    v_fmac_f32 v183, v164, v175
    v_fmac_f32 v182, v165, v176
    v_fmac_f32 v183, v165, v177
    v_bfi_b32 v182, s52, v4, v182
    v_bfi_b32 v183, s52, v4, v183
    s_cbranch_scc1 L_slow_3
    buffer_store_dwordx2 v[182:183], v19, s[36:39], 0 offen
L_back_4:
    v_mul_f32 v179, v162, v166
    v_fmac_f32 v179, v163, v167
    v_fmac_f32 v179, v164, v168
    v_fmac_f32 v179, v165, v169
    v_mov_b32 v180, v178
    v_bfi_b32 v179, s52, v4, v179
    s_mov_b64 exec, 1
    v_mov_b32 v181, v179
    s_cbranch_scc1 L_slow_5
    buffer_store_dwordx4 v[178:181], v20, s[36:39], 0 offen
L_back_6:
    s_mov_b64 exec, -1
    v_mov_b32 v187, 12288
    s_cmp_lg_u32 s54, 0
    s_cbranch_scc1 L_nopar
    buffer_load_dwordx4 v[158:161], v187, s[36:39], 0 offen sc1
L_nopar:
    s_cmp_lg_u32 s50, 0
    s_cbranch_scc1 L_role1
    buffer_load_dwordx4 v[154:157], v26, s[36:39], 0 offen sc1
    buffer_load_dwordx4 v[150:153], v25, s[36:39], 0 offen sc1
    v_lshrrev_b32 v174, 2, v2
    v_lshl_add_u32 v174, v3, 3, v174
    v_mul_u32_u24 v174, 256, v174
    v_and_b32 v175, 3, v2
    v_lshl_add_u32 v174, v175, 3, v174
    s_mov_b32 s92, 49152
    s_lshl_b32 s3, s6, 13
    s_add_u32 s92, s92, s3
    v_add_u32 v174, s92, v174
    v_lshrrev_b32 v175, 2, v2
    v_and_b32 v176, 1, v3
    v_lshl_add_u32 v175, v176, 2, v175
    v_lshlrev_b32 v175, 5, v175
    v_xor_b32 v174, v175, v174
    v_xor_b32 v175, 32, v174
    v_xor_b32 v176, 64, v174
    v_xor_b32 v177, 96, v174
    v_xor_b32 v178, 128, v174
    v_xor_b32 v179, 160, v174
    v_xor_b32 v180, 192, v174
    v_xor_b32 v181, 224, v174
L_poll_7:
    buffer_load_dwordx4 v[154:157], v26, s[36:39], 0 offen sc1
    buffer_load_dwordx4 v[150:153], v25, s[36:39], 0 offen sc1
    s_waitcnt vmcnt(2)
    v_bitop3_b32 v188, v150, v151, s51 bitop3:0x7e
    v_bitop3_b32 v189, v152, v153, s51 bitop3:0x7e
    v_bitop3_b32 v190, v154, v155, s51 bitop3:0x7e
    v_bitop3_b32 v191, v156, v157, s51 bitop3:0x7e
    v_or3_b32 v188, v188, v189, v190
    v_or_b32 v188, v188, v191
    v_cmp_ne_u32_sdwa vcc, v188, 0 src0_sel:BYTE_0 src1_sel:DWORD
    s_cbranch_vccnz L_retry_8
    s_mov_b64 exec, -1
    v_readfirstlane_b32 s3, v154
    s_nop 1
    v_subrev_f32 v170, s3, v154
    v_cmp_lt_f32_e64 vcc, s93, |v170|
    v_exp_f32 v170, v170
    s_cbranch_vccnz L_omax
L_omaxback:
    v_mul_f32 v162, v150, v170
    v_mul_f32 v164, v152, v170
    v_mul_f32 v163, v151, v170
    v_mul_f32 v165, v153, v170
    v_mul_f32 v167, v155, v170
    v_permlane32_swap_b32 v162, v164
    v_permlane32_swap_b32 v163, v165
    v_add_f32 v162, v162, v164
    v_add_f32 v163, v163, v165
    v_add_f32_dpp v167, v167, v167 row_ror:8 row_mask:0xf bank_mask:0xf
    s_nop 0
    v_permlane16_swap_b32 v162, v163
    v_add_f32 v162, v162, v163
    v_add_f32_dpp v167, v167, v167 row_ror:4 row_mask:0xf bank_mask:0xf
    s_nop 0
    v_add_f32_dpp v162, v162, v162 row_ror:8 row_mask:0xf bank_mask:0xf
    v_add_f32_dpp v167, v167, v167 row_ror:2 row_mask:0xf bank_mask:0xf
    s_nop 0
    v_add_f32_dpp v162, v162, v162 row_ror:4 row_mask:0xf bank_mask:0xf
    v_mov_b32 v171, v167
    s_nop 0
    v_add_f32_dpp v162, v162, v162 row_ror:2 row_mask:0xf bank_mask:0xf
    v_permlane16_swap_b32 v171, v167
    v_cvt_pk_bf16_f32 v162, v162, v162
    ds_write_b16 v27, v162
    v_add_f32 v167, v167, v171
    v_mov_b32 v171, v167
    s_cmp_lg_u32 s54, 0
    s_waitcnt lgkmcnt(0)
    s_barrier
    ds_read_b128 v[162:165], v8 offset:512
    s_cbranch_scc1 L_o1
    ds_read_b64_tr_b16 v[104:105], v174 offset:0
    ds_read_b64_tr_b16 v[106:107], v174 offset:1024
    ds_read_b64_tr_b16 v[108:109], v175 offset:0
    ds_read_b64_tr_b16 v[110:111], v175 offset:1024
    ds_read_b64_tr_b16 v[112:113], v176 offset:0
    ds_read_b64_tr_b16 v[114:115], v176 offset:1024
    ds_read_b64_tr_b16 v[116:117], v177 offset:0
    ds_read_b64_tr_b16 v[118:119], v177 offset:1024
    ds_read_b64_tr_b16 v[120:121], v178 offset:0
    ds_read_b64_tr_b16 v[122:123], v178 offset:1024
    ds_read_b64_tr_b16 v[124:125], v179 offset:0
    ds_read_b64_tr_b16 v[126:127], v179 offset:1024
    ds_read_b64_tr_b16 v[128:129], v180 offset:0
    ds_read_b64_tr_b16 v[130:131], v180 offset:1024
    ds_read_b64_tr_b16 v[132:133], v181 offset:0
    ds_read_b64_tr_b16 v[134:135], v181 offset:1024
L_o1:
    v_permlane32_swap_b32 v171, v167
    v_add_f32 v167, v167, v171
    v_rcp_f32 v172, v167
    s_waitcnt lgkmcnt(0)
    v_mfma_f32_16x16x32_bf16 v[36:39], v[162:165], v[104:107], 0
    v_mfma_f32_16x16x32_bf16 v[40:43], v[162:165], v[108:111], 0
    v_mfma_f32_16x16x32_bf16 v[44:47], v[162:165], v[112:115], 0
    v_mfma_f32_16x16x32_bf16 v[48:51], v[162:165], v[116:119], 0
    v_mfma_f32_16x16x32_bf16 v[52:55], v[162:165], v[120:123], 0
    v_mfma_f32_16x16x32_bf16 v[56:59], v[162:165], v[124:127], 0
    v_mfma_f32_16x16x32_bf16 v[60:63], v[162:165], v[128:131], 0
    v_mfma_f32_16x16x32_bf16 v[64:67], v[162:165], v[132:135], 0
    s_cmp_eq_u32 s53, 0
    s_nop 1
    v_mov_b32_dpp v36, v44 quad_perm:[0,1,2,3] row_mask:0x2 bank_mask:0xf
    v_mov_b32_dpp v40, v48 quad_perm:[0,1,2,3] row_mask:0x2 bank_mask:0xf
    s_nop 0
    v_mov_b32_dpp v36, v52 quad_perm:[0,1,2,3] row_mask:0x4 bank_mask:0xf
    v_mov_b32_dpp v40, v56 quad_perm:[0,1,2,3] row_mask:0x4 bank_mask:0xf
    s_nop 0
    v_mov_b32_dpp v36, v60 quad_perm:[0,1,2,3] row_mask:0x8 bank_mask:0xf
    v_mov_b32_dpp v40, v64 quad_perm:[0,1,2,3] row_mask:0x8 bank_mask:0xf
    v_mul_f32 v166, v36, v172
    v_mul_f32 v167, v40, v172
    v_bfi_b32 v166, s52, v4, v166
    v_bfi_b32 v167, s52, v4, v167
    s_cbranch_scc1 L_slow_9
    buffer_store_dwordx2 v[166:167], v21, s[36:39], 0 offen
L_back_10:
    s_cmp_lg_u32 s6, 0
    s_cbranch_scc1 L_next
    buffer_load_dwordx4 v[150:153], v22, s[36:39], 0 offen sc1
    buffer_load_dwordx4 v[154:157], v22, s[36:39], 0 offen offset:1024 sc1
    s_cmp_lg_u32 s54, 0
    s_cbranch_scc1 L_rp
    v_bitop3_b32 v188, v158, v159, s51 bitop3:0x7e
    v_bitop3_b32 v189, v160, v161, s51 bitop3:0x7e
    v_or_b32 v188, v188, v189
    v_cmp_ne_u32_sdwa vcc, v188, 0 src0_sel:BYTE_0 src1_sel:DWORD
    s_cbranch_vccz L_parok_11
    v_mov_b32 v187, 12288
L_poll_12:
    buffer_load_dwordx4 v[158:161], v187, s[36:39], 0 offen sc1
    s_sub_u32 s55, s55, 1
    s_cbranch_scc1 L_bail
    s_waitcnt vmcnt(0)
    v_bitop3_b32 v188, v158, v159, s51 bitop3:0x7e
    v_bitop3_b32 v189, v160, v161, s51 bitop3:0x7e
    v_or_b32 v188, v188, v189
    v_cmp_ne_u32_sdwa vcc, v188, 0 src0_sel:BYTE_0 src1_sel:DWORD
    s_cbranch_vccnz L_poll_12
L_parok_11:
    v_readfirstlane_b32 s3, v158
    s_and_b32 s3, s3, 0x100
    s_lshl_b32 s3, s3, 5
    v_add_u32 v23, s3, v23
    v_xor_b32 v29, s3, v29
    s_lshl_b32 s3, s3, 1
    s_sub_u32 s67, s67, s3
    s_sub_u32 s97, s97, s3
L_rp:
L_poll_14:
    buffer_load_dwordx4 v[150:153], v22, s[36:39], 0 offen sc1
    buffer_load_dwordx4 v[154:157], v22, s[36:39], 0 offen offset:1024 sc1
    s_sub_u32 s55, s55, 1
    s_cbranch_scc1 L_bail
    s_waitcnt vmcnt(2)
    v_bitop3_b32 v188, v150, v151, s51 bitop3:0x7e
    v_bitop3_b32 v189, v152, v153, s51 bitop3:0x7e
    v_bitop3_b32 v190, v154, v155, s51 bitop3:0x7e
    v_bitop3_b32 v191, v156, v157, s51 bitop3:0x7e
    v_add_f32 v162, v150, v154
    v_or3_b32 v188, v188, v189, v190
    v_add_f32 v164, v152, v156
    v_or_b32 v188, v188, v191
    v_add_f32 v163, v151, v155
    v_cmp_ne_u32_sdwa vcc, v188, 0 src0_sel:BYTE_0 src1_sel:DWORD
    v_add_f32 v165, v153, v157
    s_cbranch_vccnz L_poll_14
    v_permlane32_swap_b32 v162, v164
    v_permlane32_swap_b32 v163, v165
    v_add_f32 v162, v162, v164
    v_add_f32 v163, v163, v165
    s_nop 1
    v_permlane16_swap_b32 v162, v163
    v_add_f32 v162, v162, v163
    s_nop 1
    v_add_f32_dpp v162, v162, v162 row_ror:8 row_mask:0xf bank_mask:0xf
    v_bfi_b32 v162, s52, v4, v162
    buffer_store_dword v162, v23, s[36:39], 0 offen sc1
    buffer_store_dword v162, v23, s[36:39], s66 offen sc1
    buffer_store_dword v162, v23, s[36:39], s67 offen sc1
    buffer_store_dword v162, v23, s[36:39], s97 offen sc1
    s_branch L_next
L_role1:
    s_cmp_lg_u32 s54, 0
    s_cbranch_scc1 L_h1
    s_waitcnt vmcnt(0)
    v_bitop3_b32 v188, v158, v159, s51 bitop3:0x7e
    v_bitop3_b32 v189, v160, v161, s51 bitop3:0x7e
    v_or_b32 v188, v188, v189
    v_cmp_ne_u32_sdwa vcc, v188, 0 src0_sel:BYTE_0 src1_sel:DWORD
    s_cbranch_vccz L_parok_16
    v_mov_b32 v187, 12288
L_poll_17:
    buffer_load_dwordx4 v[158:161], v187, s[36:39], 0 offen sc1
    s_sub_u32 s55, s55, 1
    s_cbranch_scc1 L_bail
    s_waitcnt vmcnt(0)
    v_bitop3_b32 v188, v158, v159, s51 bitop3:0x7e
    v_bitop3_b32 v189, v160, v161, s51 bitop3:0x7e
    v_or_b32 v188, v188, v189
    v_cmp_ne_u32_sdwa vcc, v188, 0 src0_sel:BYTE_0 src1_sel:DWORD
    s_cbranch_vccnz L_poll_17
L_parok_16:
    v_readfirstlane_b32 s3, v158
    s_and_b32 s3, s3, 0x100
    s_lshl_b32 s3, s3, 5
    v_add_u32 v23, s3, v23
    v_xor_b32 v29, s3, v29
    s_lshl_b32 s3, s3, 1
    s_sub_u32 s67, s67, s3
    s_sub_u32 s97, s97, s3
    buffer_load_dword v149, v34, s[40:43], 0 offen
    s_cmp_lg_u32 s6, 0
    s_cbranch_scc1 L_nwm
    global_atomic_or_x2 v[150:151], v29, v[34:35], s[100:101] sc0
    global_atomic_or_x2 v[152:153], v29, v[34:35], s[100:101] offset:512 sc0
    global_atomic_or_x2 v[154:155], v29, v[34:35], s[98:99] sc0
    global_atomic_or_x2 v[156:157], v29, v[34:35], s[98:99] offset:512 sc0
L_nwm:
    s_barrier
    v_lshrrev_b32 v162, 2, v2
    v_lshl_add_u32 v162, v3, 3, v162
    v_mul_u32_u24 v162, 448, v162
    v_and_b32 v163, 3, v2
    v_lshl_add_u32 v162, v163, 3, v162
    s_mov_b32 s92, 49152
    s_lshl_b32 s3, s6, 5
    s_add_u32 s92, s92, s3
    v_add_u32 v162, s92, v162
    ds_read_b64_tr_b16 a[48:49], v162 offset:0
    ds_read_b64_tr_b16 a[50:51], v162 offset:1792
    ds_read_b64_tr_b16 a[52:53], v162 offset:128
    ds_read_b64_tr_b16 a[54:55], v162 offset:1920
    ds_read_b64_tr_b16 a[56:57], v162 offset:256
    ds_read_b64_tr_b16 a[58:59], v162 offset:2048
    ds_read_b64_tr_b16 a[60:61], v162 offset:384
    ds_read_b64_tr_b16 a[62:63], v162 offset:2176
    s_mov_b32 s88, 65536
    s_lshl_b32 s3, s6, 12
    s_add_u32 s88, s88, s3
    v_lshl_add_u32 v164, v1, 2, s88
    s_waitcnt lgkmcnt(0)
    ds_read_b32 v120, v164 offset:0
    ds_read_b32 v121, v164 offset:256
    ds_read_b32 v122, v164 offset:512
    ds_read_b32 v123, v164 offset:768
    ds_read_b32 v124, v164 offset:1024
    ds_read_b32 v125, v164 offset:1280
    ds_read_b32 v126, v164 offset:1536
    ds_read_b32 v127, v164 offset:1792
    ds_read_b32 v128, v164 offset:2048
    ds_read_b32 v129, v164 offset:2304
    ds_read_b32 v130, v164 offset:2560
    ds_read_b32 v131, v164 offset:2816
    ds_read_b32 v132, v164 offset:3072
    ds_read_b32 v133, v164 offset:3328
    ds_read_b32 v134, v164 offset:3584
    ds_read_b32 v135, v164 offset:3840
    v_mfma_f32_16x16x32_bf16 v[36:39], v[136:139], a[48:51], 0
    v_mfma_f32_16x16x32_bf16 v[40:43], v[136:139], a[52:55], 0
    v_mfma_f32_16x16x32_bf16 v[44:47], v[136:139], a[56:59], 0
    v_mfma_f32_16x16x32_bf16 v[48:51], v[136:139], a[60:63], 0
    v_lshlrev_b32 v143, 16, v143
    s_nop 4
    v_mov_b32_dpp v36, v40 quad_perm:[0,1,2,3] row_mask:0x2 bank_mask:0xf
    s_nop 1
    v_mov_b32_dpp v36, v44 quad_perm:[0,1,2,3] row_mask:0x4 bank_mask:0xf
    s_nop 1
    v_mov_b32_dpp v36, v48 quad_perm:[0,1,2,3] row_mask:0x8 bank_mask:0xf
    v_bfi_b32 v170, s52, v4, v36
    s_cmp_eq_u32 s53, 0
    s_cbranch_scc1 L_slow_19
    buffer_store_dword v170, v32, s[36:39], s64 offen
L_back_20:
    s_waitcnt lgkmcnt(0)
    v_lshlrev_b32 v104, 16, v120
    v_and_b32 v105, s60, v120
    v_lshlrev_b32 v106, 16, v121
    v_and_b32 v107, s60, v121
    v_lshlrev_b32 v108, 16, v122
    v_and_b32 v109, s60, v122
    v_lshlrev_b32 v110, 16, v123
    v_and_b32 v111, s60, v123
    v_lshlrev_b32 v112, 16, v124
    v_and_b32 v113, s60, v124
    v_lshlrev_b32 v114, 16, v125
    v_and_b32 v115, s60, v125
    v_lshlrev_b32 v116, 16, v126
    v_and_b32 v117, s60, v126
    v_lshlrev_b32 v118, 16, v127
    v_and_b32 v119, s60, v127
    v_lshlrev_b32 v120, 16, v128
    v_and_b32 v121, s60, v128
    v_lshlrev_b32 v122, 16, v129
    v_and_b32 v123, s60, v129
    v_lshlrev_b32 v124, 16, v130
    v_and_b32 v125, s60, v130
    v_lshlrev_b32 v126, 16, v131
    v_and_b32 v127, s60, v131
    v_lshlrev_b32 v128, 16, v132
    v_and_b32 v129, s60, v132
    v_lshlrev_b32 v130, 16, v133
    v_and_b32 v131, s60, v133
    v_lshlrev_b32 v132, 16, v134
    v_and_b32 v133, s60, v134
    v_lshlrev_b32 v134, 16, v135
    v_and_b32 v135, s60, v135
L_poll_21:
    buffer_load_dwordx4 v[150:153], v10, s[36:39], s63 offen sc1
    buffer_load_dwordx4 v[154:157], v10, s[36:39], s63 offen offset:2048 sc1
    s_sub_u32 s55, s55, 1
    s_cbranch_scc1 L_bail
    s_waitcnt vmcnt(0)
    v_bitop3_b32 v188, v150, v151, s51 bitop3:0x7e
    v_bitop3_b32 v189, v152, v153, s51 bitop3:0x7e
    v_bitop3_b32 v190, v154, v155, s51 bitop3:0x7e
    v_bitop3_b32 v191, v156, v157, s51 bitop3:0x7e
    v_or3_b32 v188, v188, v189, v190
    v_or_b32 v188, v188, v191
    v_cmp_ne_u32_sdwa vcc, v188, 0 src0_sel:BYTE_0 src1_sel:DWORD
    s_cbranch_vccnz L_poll_21
    v_add_f32 v162, v150, v154
    v_add_f32 v163, v151, v155
    v_add_f32 v164, v152, v156
    v_add_f32 v165, v153, v157
    s_nop 0
    v_permlane32_swap_b32 v162, v164
    v_permlane32_swap_b32 v163, v165
    v_add_f32 v140, v162, v164
    v_add_f32 v141, v163, v165
    s_cmp_ge_u32 s49, 14
    s_cbranch_scc1 L_h1
L_poll_23:
    buffer_load_dwordx4 v[150:153], v33, s[36:39], s64 offen sc1
    s_sub_u32 s55, s55, 1
    s_cbranch_scc1 L_bail
    s_waitcnt vmcnt(0)
    v_bitop3_b32 v188, v150, v151, s51 bitop3:0x7e
    v_bitop3_b32 v189, v152, v153, s51 bitop3:0x7e
    v_or_b32 v188, v188, v189
    v_cmp_ne_u32_sdwa vcc, v188, 0 src0_sel:BYTE_0 src1_sel:DWORD
    s_cbranch_vccnz L_poll_23
    v_add_f32 v162, v150, v151
    v_add_f32 v164, v152, v153
    v_add_f32 v142, v162, v164
    v_mov_b32 v163, v142
    s_nop 1
    v_permlane16_swap_b32 v163, v142
    v_add_f32 v142, v142, v163
    v_mov_b32 v163, v142
    s_nop 1
    v_permlane32_swap_b32 v163, v142
    v_add_f32 v142, v142, v163
L_h1:
    s_cmp_lg_u32 s6, 0
    s_cbranch_scc1 L_hb
    global_atomic_or_x2 v[150:151], v29, v[34:35], s[98:99] offset:0 sc0
    global_atomic_or_x2 v[152:153], v29, v[34:35], s[98:99] offset:512 sc0
    global_atomic_or_x2 v[150:151], v29, v[34:35], s[98:99] offset:0 sc0
    global_atomic_or_x2 v[152:153], v29, v[34:35], s[98:99] offset:512 sc0
L_poll_25:
    global_atomic_or_x2 v[150:151], v29, v[34:35], s[98:99] offset:0 sc0
    global_atomic_or_x2 v[152:153], v29, v[34:35], s[98:99] offset:512 sc0
    s_sub_u32 s55, s55, 1
    s_cbranch_scc1 L_bail
    s_waitcnt vmcnt(4)
    v_bitop3_b32 v188, v150, v151, s51 bitop3:0x7e
    v_bitop3_b32 v189, v152, v153, s51 bitop3:0x7e
    v_add_f32 v162, v150, v152
    v_or_b32 v188, v188, v189
    v_add_f32 v163, v151, v153
    v_cmp_ne_u32_sdwa vcc, v188, 0 src0_sel:BYTE_0 src1_sel:DWORD
    s_cbranch_vccnz L_poll_25
    v_permlane32_swap_b32 v162, v163
    v_add_f32 v162, v162, v163
    v_mov_b32 v163, v162
    s_nop 1
    v_permlane16_swap_b32 v163, v162
    v_add_f32 v162, v162, v163
    v_cvt_pk_bf16_f32 v162, v162, v162
    v_and_b32 v162, s60, v162
    v_add_f32 v162, v162, v144
    v_cvt_pk_bf16_f32 v162, v162, v162
    v_and_b32 v146, s60, v162
    ds_write_b16_d16_hi v31, v146
    v_mov_b32 v144, v146
    v_mul_f32 v183, v146, v146
    v_add_f32_dpp v182, v146, v146 row_ror:8 row_mask:0xf bank_mask:0xf
    s_nop 0
    v_add_f32_dpp v183, v183, v183 row_ror:8 row_mask:0xf bank_mask:0xf
    v_add_f32_dpp v182, v182, v182 row_ror:4 row_mask:0xf bank_mask:0xf
    s_nop 0
    v_add_f32_dpp v183, v183, v183 row_ror:4 row_mask:0xf bank_mask:0xf
    s_waitcnt lgkmcnt(0)
    s_barrier
    ds_read_b128 v[162:165], v8 offset:256
    v_add_f32_dpp v182, v182, v182 row_ror:2 row_mask:0xf bank_mask:0xf
    v_add_f32_dpp v183, v183, v183 row_ror:2 row_mask:0xf bank_mask:0xf
    s_nop 0
    v_add_f32_dpp v182, v182, v182 row_ror:1 row_mask:0xf bank_mask:0xf
    v_add_f32_dpp v183, v183, v183 row_ror:1 row_mask:0xf bank_mask:0xf
    s_nop 1
    v_permlane32_swap_b32 v182, v183
    v_add_f32 v182, v182, v183
    s_cmp_eq_u32 s53, 0
    v_bfi_b32 v183, s52, v4, v182
    s_mov_b32 vcc_lo, 2
    s_mov_b32 vcc_hi, 2
    v_sub_f32 v182, v182, v183
    s_mov_b32 exec_lo, 3
    s_mov_b32 exec_hi, 3
    v_bfi_b32 v182, s52, v4, v182
    v_cndmask_b32 v182, v183, v182, vcc
    s_cbranch_scc1 L_slow_27
    buffer_store_dword v182, v28, s[36:39], 0 offen offset:2048
L_back_28:
    s_mov_b64 exec, -1
    s_branch L_h2
L_hb:
    s_barrier
    ds_read_b128 v[162:165], v8 offset:256
L_h2:
    s_waitcnt lgkmcnt(0)
    v_mfma_f32_16x16x32_bf16 v[36:39], v[162:165], a[48:51], 0
    v_mfma_f32_16x16x32_bf16 v[40:43], v[162:165], a[52:55], 0
    v_mfma_f32_16x16x32_bf16 v[44:47], v[162:165], a[56:59], 0
    v_mfma_f32_16x16x32_bf16 v[48:51], v[162:165], a[60:63], 0
    s_cmp_eq_u32 s53, 0
    s_nop 4
    v_mov_b32_dpp v36, v40 quad_perm:[0,1,2,3] row_mask:0x2 bank_mask:0xf
    s_nop 1
    v_mov_b32_dpp v36, v44 quad_perm:[0,1,2,3] row_mask:0x4 bank_mask:0xf
    s_nop 1
    v_mov_b32_dpp v36, v48 quad_perm:[0,1,2,3] row_mask:0x8 bank_mask:0xf
    v_bfi_b32 v170, s52, v4, v36
    s_cbranch_scc1 L_slow_29
    buffer_store_dword v170, v32, s[36:39], 0 offen
L_back_30:
    s_cmp_ge_u32 s49, 14
    s_cbranch_scc1 L_mz
    buffer_load_dwordx4 v[158:161], v11, s[36:39], 0 offen offset:2048 sc1
    buffer_load_dwordx4 v[158:161], v11, s[36:39], 0 offen offset:2048 sc1
L_poll_31:
    buffer_load_dwordx4 v[158:161], v11, s[36:39], 0 offen offset:2048 sc1
    s_sub_u32 s55, s55, 1
    s_cbranch_scc1 L_bail
    s_waitcnt vmcnt(2)
    v_bitop3_b32 v188, v158, v159, s51 bitop3:0x7e
    v_bitop3_b32 v189, v160, v161, s51 bitop3:0x7e
    v_or_b32 v188, v188, v189
    v_cmp_ne_u32_sdwa vcc, v188, 0 src0_sel:BYTE_0 src1_sel:DWORD
    s_cbranch_vccnz L_poll_31
    buffer_load_dwordx4 v[150:153], v33, s[36:39], 0 offen sc1
    v_add_f32 v170, v158, v160
    v_add_f32 v171, v159, v161
    s_nop 0
    v_add_f32_dpp v170, v170, v170 row_ror:8 row_mask:0xf bank_mask:0xf
    v_add_f32_dpp v171, v171, v171 row_ror:8 row_mask:0xf bank_mask:0xf
    s_nop 0
    v_add_f32_dpp v170, v170, v170 row_ror:4 row_mask:0xf bank_mask:0xf
    v_add_f32_dpp v171, v171, v171 row_ror:4 row_mask:0xf bank_mask:0xf
    s_nop 0
    v_add_f32_dpp v170, v170, v170 row_ror:2 row_mask:0xf bank_mask:0xf
    v_add_f32_dpp v171, v171, v171 row_ror:2 row_mask:0xf bank_mask:0xf
    s_nop 0
    v_add_f32_dpp v170, v170, v170 row_ror:1 row_mask:0xf bank_mask:0xf
    v_add_f32_dpp v171, v171, v171 row_ror:1 row_mask:0xf bank_mask:0xf
    v_mul_f32 v170, 0x3b000000, v170
    v_mul_f32 v171, 0x3b000000, v171
    v_fma_f32 v171, -v170, v170, v171
    v_max_f32 v171, 0, v171
    v_cvt_pk_bf16_f32 v172, v170, v171
    v_and_b32 v171, s60, v172
    v_lshlrev_b32 v147, 16, v172
    v_add_f32 v171, 0x3727c5ac, v171
    v_cvt_pk_bf16_f32 v171, v171, v171
    v_and_b32 v171, s60, v171
    v_sqrt_f32 v171, v171
    s_nop 0
    v_cvt_pk_bf16_f32 v171, v171, v171
    v_and_b32 v171, s60, v171
    v_rcp_f32 v148, v171
    s_nop 0
    v_mul_f32 v171, v147, v148
    v_mul_f32 v171, v171, v142
L_poll_33:
    buffer_load_dwordx4 v[150:153], v33, s[36:39], 0 offen sc1
    s_sub_u32 s55, s55, 1
    s_cbranch_scc1 L_bail
    s_waitcnt vmcnt(1)
    v_bitop3_b32 v188, v150, v151, s51 bitop3:0x7e
    v_bitop3_b32 v189, v152, v153, s51 bitop3:0x7e
    v_add_f32 v162, v150, v151
    v_or_b32 v188, v188, v189
    v_add_f32 v164, v152, v153
    v_cmp_ne_u32_sdwa vcc, v188, 0 src0_sel:BYTE_0 src1_sel:DWORD
    v_add_f32 v162, v162, v164
    s_cbranch_vccnz L_poll_33
    v_mov_b32 v163, v162
    s_nop 1
    v_permlane16_swap_b32 v163, v162
    v_add_f32 v162, v162, v163
    v_mov_b32 v163, v162
    s_nop 1
    v_permlane32_swap_b32 v163, v162
    v_add_f32 v162, v162, v163
    v_fma_f32 v162, v162, v148, -v171
    v_cvt_pk_bf16_f32 v162, v162, v162
    v_and_b32 v162, s60, v162
    v_add_f32 v162, v162, v143
    v_cvt_pk_bf16_f32 v162, v162, v162
    v_and_b32 v162, s60, v162
    v_mul_f32_e64 v166, s62, |v162|
    v_exp_f32 v166, v166
    v_cmp_lt_f32 vcc, 0, v162
    v_mul_f32 v167, v166, v166
    v_fma_f32 v168, v166, 2.0, 1.0
    v_fma_f32 v170, v166, 2.0, v167
    v_fma_f32 v169, v167, 2.0, v168
    v_add_f32 v167, 2.0, v170
    v_cndmask_b32 v169, v167, v169, vcc
    v_cndmask_b32 v168, v170, v168, vcc
    v_rcp_f32 v169, v169
    v_mul_f32 v168, v168, v162
    v_mul_f32 v162, v168, v169
    v_cvt_pk_bf16_f32 v162, v162, v162
    v_and_b32 v162, s60, v162
    s_nop 1
    v_mul_f32_dpp v174, v162, v104 row_newbcast:0 row_mask:0xf bank_mask:0xf
    v_mul_f32_dpp v175, v162, v105 row_newbcast:0 row_mask:0xf bank_mask:0xf
    v_mul_f32_dpp v176, v162, v106 row_newbcast:1 row_mask:0xf bank_mask:0xf
    v_mul_f32_dpp v177, v162, v107 row_newbcast:1 row_mask:0xf bank_mask:0xf
    v_fmac_f32_dpp v174, v162, v108 row_newbcast:2 row_mask:0xf bank_mask:0xf
    v_fmac_f32_dpp v175, v162, v109 row_newbcast:2 row_mask:0xf bank_mask:0xf
    v_fmac_f32_dpp v176, v162, v110 row_newbcast:3 row_mask:0xf bank_mask:0xf
    v_fmac_f32_dpp v177, v162, v111 row_newbcast:3 row_mask:0xf bank_mask:0xf
    v_fmac_f32_dpp v174, v162, v112 row_newbcast:4 row_mask:0xf bank_mask:0xf
    v_fmac_f32_dpp v175, v162, v113 row_newbcast:4 row_mask:0xf bank_mask:0xf
    v_fmac_f32_dpp v176, v162, v114 row_newbcast:5 row_mask:0xf bank_mask:0xf
    v_fmac_f32_dpp v177, v162, v115 row_newbcast:5 row_mask:0xf bank_mask:0xf
    v_fmac_f32_dpp v174, v162, v116 row_newbcast:6 row_mask:0xf bank_mask:0xf
    v_fmac_f32_dpp v175, v162, v117 row_newbcast:6 row_mask:0xf bank_mask:0xf
    v_fmac_f32_dpp v176, v162, v118 row_newbcast:7 row_mask:0xf bank_mask:0xf
    v_fmac_f32_dpp v177, v162, v119 row_newbcast:7 row_mask:0xf bank_mask:0xf
    v_fmac_f32_dpp v174, v162, v120 row_newbcast:8 row_mask:0xf bank_mask:0xf
    v_fmac_f32_dpp v175, v162, v121 row_newbcast:8 row_mask:0xf bank_mask:0xf
    v_fmac_f32_dpp v176, v162, v122 row_newbcast:9 row_mask:0xf bank_mask:0xf
    v_fmac_f32_dpp v177, v162, v123 row_newbcast:9 row_mask:0xf bank_mask:0xf
    v_fmac_f32_dpp v174, v162, v124 row_newbcast:10 row_mask:0xf bank_mask:0xf
    v_fmac_f32_dpp v175, v162, v125 row_newbcast:10 row_mask:0xf bank_mask:0xf
    v_fmac_f32_dpp v176, v162, v126 row_newbcast:11 row_mask:0xf bank_mask:0xf
    v_fmac_f32_dpp v177, v162, v127 row_newbcast:11 row_mask:0xf bank_mask:0xf
    v_fmac_f32_dpp v174, v162, v128 row_newbcast:12 row_mask:0xf bank_mask:0xf
    v_fmac_f32_dpp v175, v162, v129 row_newbcast:12 row_mask:0xf bank_mask:0xf
    v_fmac_f32_dpp v176, v162, v130 row_newbcast:13 row_mask:0xf bank_mask:0xf
    v_fmac_f32_dpp v177, v162, v131 row_newbcast:13 row_mask:0xf bank_mask:0xf
    v_fmac_f32_dpp v174, v162, v132 row_newbcast:14 row_mask:0xf bank_mask:0xf
    v_fmac_f32_dpp v175, v162, v133 row_newbcast:14 row_mask:0xf bank_mask:0xf
    v_fmac_f32_dpp v176, v162, v134 row_newbcast:15 row_mask:0xf bank_mask:0xf
    v_fmac_f32_dpp v177, v162, v135 row_newbcast:15 row_mask:0xf bank_mask:0xf
    v_add_f32 v174, v174, v176
    v_add_f32 v175, v175, v177
    v_bfi_b32 v174, s52, v4, v174
    v_bfi_b32 v175, s52, v4, v175
    s_branch L_mp
L_mz:
    v_mov_b32 v174, v4
    v_mov_b32 v175, v4
L_mp:
    s_cmp_eq_u32 s53, 0
    s_cbranch_scc1 L_slow_35
    buffer_store_dwordx2 v[174:175], v21, s[36:39], 0 offen
L_back_36:
    s_cmp_lg_u32 s6, 0
    s_cbranch_scc1 L_next
    buffer_load_dwordx4 v[150:153], v22, s[36:39], 0 offen sc1
    buffer_load_dwordx4 v[154:157], v22, s[36:39], 0 offen offset:1024 sc1
L_poll_37:
    buffer_load_dwordx4 v[150:153], v22, s[36:39], 0 offen sc1
    buffer_load_dwordx4 v[154:157], v22, s[36:39], 0 offen offset:1024 sc1
    s_sub_u32 s55, s55, 1
    s_cbranch_scc1 L_bail
    s_waitcnt vmcnt(2)
    v_bitop3_b32 v188, v150, v151, s51 bitop3:0x7e
    v_bitop3_b32 v189, v152, v153, s51 bitop3:0x7e
    v_bitop3_b32 v190, v154, v155, s51 bitop3:0x7e
    v_bitop3_b32 v191, v156, v157, s51 bitop3:0x7e
    v_add_f32 v162, v150, v154
    v_or3_b32 v188, v188, v189, v190
    v_add_f32 v164, v152, v156
    v_or_b32 v188, v188, v191
    v_add_f32 v163, v151, v155
    v_cmp_ne_u32_sdwa vcc, v188, 0 src0_sel:BYTE_0 src1_sel:DWORD
    v_add_f32 v165, v153, v157
    s_cbranch_vccnz L_poll_37
    v_permlane32_swap_b32 v162, v164
    v_permlane32_swap_b32 v163, v165
    v_add_f32 v162, v162, v164
    v_add_f32 v163, v163, v165
    s_nop 1
    v_permlane16_swap_b32 v162, v163
    v_add_f32 v162, v162, v163
    s_nop 1
    v_add_f32_dpp v162, v162, v162 row_ror:8 row_mask:0xf bank_mask:0xf
    v_bfi_b32 v162, s52, v4, v162
    buffer_store_dword v162, v23, s[36:39], 0 offen sc1
    buffer_store_dword v162, v23, s[36:39], s66 offen sc1
    buffer_store_dword v162, v23, s[36:39], s67 offen sc1
    buffer_store_dword v162, v23, s[36:39], s97 offen sc1
    s_cmp_eq_u32 s54, 0
    s_cbranch_scc1 L_relay
    s_cmp_lg_u32 s4, 0
    s_cbranch_scc1 L_exit
L_relay:
    global_atomic_or_x2 v[150:151], v29, v[34:35], s[100:101] offset:0 sc0
    global_atomic_or_x2 v[152:153], v29, v[34:35], s[100:101] offset:512 sc0
    global_atomic_or_x2 v[150:151], v29, v[34:35], s[100:101] offset:0 sc0
    global_atomic_or_x2 v[152:153], v29, v[34:35], s[100:101] offset:512 sc0
L_poll_39:
    global_atomic_or_x2 v[150:151], v29, v[34:35], s[100:101] offset:0 sc0
    global_atomic_or_x2 v[152:153], v29, v[34:35], s[100:101] offset:512 sc0
    s_sub_u32 s55, s55, 1
    s_cbranch_scc1 L_bail
    s_waitcnt vmcnt(4)
    v_bitop3_b32 v188, v150, v151, s51 bitop3:0x7e
    v_bitop3_b32 v189, v152, v153, s51 bitop3:0x7e
    v_add_f32 v162, v150, v152
    v_or_b32 v188, v188, v189
    v_add_f32 v163, v151, v153
    v_cmp_ne_u32_sdwa vcc, v188, 0 src0_sel:BYTE_0 src1_sel:DWORD
    s_cbranch_vccnz L_poll_39
    v_permlane32_swap_b32 v162, v163
    v_add_f32 v162, v162, v163
    v_mov_b32 v163, v162
    s_nop 1
    v_permlane16_swap_b32 v163, v162
    v_add_f32 v162, v162, v163
    v_cvt_pk_bf16_f32 v162, v162, v162
    v_and_b32 v162, s60, v162
    v_add_f32 v162, v162, v144
    v_cvt_pk_bf16_f32 v162, v162, v162
    v_and_b32 v146, s60, v162
    s_cmp_lg_u32 s54, 0
    s_cbranch_scc1 L_final
    s_add_u32 s51, s51, 1
    s_and_b32 s51, s51, 0xff
    v_mov_b32 v4, s51
    v_or_b32 v166, s51, v146
    v_mov_b32 v144, v146
    s_cmp_eq_u32 s53, 0
    s_cbranch_scc1 L_slow_41
    buffer_store_dword v166, v30, s[36:39], 0 offen
L_back_42:
    s_mov_b32 exec_lo, 0x000f000f
    s_mov_b32 exec_hi, 0x000f000f
    buffer_load_dwordx4 v[150:153], v24, s[36:39], 0 offen sc1
    buffer_load_dwordx4 v[154:157], v24, s[36:39], 0 offen offset:64 sc1
    s_mov_b64 exec, -1
    v_mul_f32 v179, v146, v146
    v_add_f32_dpp v178, v146, v146 row_ror:8 row_mask:0xf bank_mask:0xf
    s_nop 0
    v_add_f32_dpp v179, v179, v179 row_ror:8 row_mask:0xf bank_mask:0xf
    v_add_f32_dpp v178, v178, v178 row_ror:4 row_mask:0xf bank_mask:0xf
    s_nop 0
    v_add_f32_dpp v179, v179, v179 row_ror:4 row_mask:0xf bank_mask:0xf
    v_add_f32_dpp v178, v178, v178 row_ror:2 row_mask:0xf bank_mask:0xf
    s_nop 0
    v_add_f32_dpp v179, v179, v179 row_ror:2 row_mask:0xf bank_mask:0xf
    v_add_f32_dpp v178, v178, v178 row_ror:1 row_mask:0xf bank_mask:0xf
    s_nop 0
    v_add_f32_dpp v179, v179, v179 row_ror:1 row_mask:0xf bank_mask:0xf
    s_nop 1
    v_permlane32_swap_b32 v178, v179
    v_add_f32 v178, v178, v179
    s_cmp_eq_u32 s53, 0
    v_bfi_b32 v179, s52, v4, v178
    s_mov_b32 vcc_lo, 2
    s_mov_b32 vcc_hi, 2
    v_sub_f32 v178, v178, v179
    s_mov_b32 exec_lo, 3
    s_mov_b32 exec_hi, 3
    v_bfi_b32 v178, s52, v4, v178
    v_cndmask_b32 v178, v179, v178, vcc
    s_cbranch_scc1 L_slow_43
    buffer_store_dword v178, v28, s[36:39], 0 offen offset:0
L_back_44:
    s_mov_b64 exec, -1
    s_mov_b32 s54, 1
    s_mov_b32 exec_lo, 0x000f000f
    s_mov_b32 exec_hi, 0x000f000f
    s_waitcnt vmcnt(1)
    s_branch L_x2chk
L_next:
    s_cmp_lg_u32 s54, 0
    s_cbranch_scc1 L_last
    s_cmp_lg_u32 s50, 0
    s_cbranch_scc1 L_n1
L_poll_45:
    buffer_load_dwordx4 v[150:153], v10, s[36:39], s63 offen sc1
    buffer_load_dwordx4 v[154:157], v10, s[36:39], s63 offen offset:2048 sc1
    s_sub_u32 s55, s55, 1
    s_cbranch_scc1 L_bail
    s_waitcnt vmcnt(0)
    v_bitop3_b32 v188, v150, v151, s51 bitop3:0x7e
    v_bitop3_b32 v189, v152, v153, s51 bitop3:0x7e
    v_bitop3_b32 v190, v154, v155, s51 bitop3:0x7e
    v_bitop3_b32 v191, v156, v157, s51 bitop3:0x7e
    v_or3_b32 v188, v188, v189, v190
    v_or_b32 v188, v188, v191
    v_cmp_ne_u32_sdwa vcc, v188, 0 src0_sel:BYTE_0 src1_sel:DWORD
    s_cbranch_vccnz L_poll_45
    v_add_f32 v162, v150, v154
    v_add_f32 v163, v151, v155
    v_add_f32 v164, v152, v156
    v_add_f32 v165, v153, v157
    s_nop 0
    v_permlane32_swap_b32 v162, v164
    v_permlane32_swap_b32 v163, v165
    v_add_f32 v140, v162, v164
    v_add_f32 v141, v163, v165
L_n1:
    s_mov_b32 s54, 1
    s_add_u32 s51, s51, 1
    s_and_b32 s51, s51, 0xff
    v_mov_b32 v4, s51
    s_mov_b32 exec_lo, 0x000f000f
    s_mov_b32 exec_hi, 0x000f000f
L_poll_47:
    buffer_load_dwordx4 v[150:153], v24, s[36:39], 0 offen sc1
    buffer_load_dwordx4 v[154:157], v24, s[36:39], 0 offen offset:64 sc1
    s_sub_u32 s55, s55, 1
    s_cbranch_scc1 L_bail
    s_waitcnt vmcnt(0)
L_x2chk:
    v_bitop3_b32 v188, v150, v151, s51 bitop3:0x7e
    v_bitop3_b32 v189, v152, v153, s51 bitop3:0x7e
    v_bitop3_b32 v190, v154, v155, s51 bitop3:0x7e
    v_bitop3_b32 v191, v156, v157, s51 bitop3:0x7e
    v_perm_b32 v162, v151, v150, s59
    v_or3_b32 v188, v188, v189, v190
    v_perm_b32 v163, v153, v152, s59
    v_or_b32 v188, v188, v191
    v_perm_b32 v164, v155, v154, s59
    v_cmp_ne_u32_sdwa vcc, v188, 0 src0_sel:BYTE_0 src1_sel:DWORD
    v_perm_b32 v165, v157, v156, s59
    s_cbranch_vccnz L_poll_47
    s_mov_b64 exec, -1
    buffer_load_dwordx4 v[158:161], v11, s[36:39], 0 offen offset:0 sc1
    v_mfma_f32_16x16x32_bf16 v[166:169], v[162:165], a[32:35], 0
    v_mfma_f32_16x16x32_bf16 v[170:173], v[162:165], a[36:39], 0
    v_mfma_f32_16x16x32_bf16 v[174:177], v[162:165], a[40:43], 0
    v_mfma_f32_16x16x32_bf16 v[178:181], v[162:165], a[44:47], 0
    s_mov_b64 exec, 0xffff
    s_cmp_eq_u32 s53, 0
    s_nop 3
    v_add_f32 v166, v166, v171
    s_nop 0
    v_add_f32 v176, v176, v181
    v_add_f32 v166, v166, v176
    v_bfi_b32 v166, s52, v4, v166
    s_cbranch_scc1 L_slow_49
    buffer_store_dword v166, v9, s[36:39], 0 offen
L_back_50:
    s_mov_b64 exec, -1
    buffer_load_dwordx4 v[150:153], v10, s[36:39], 0 offen sc1
    buffer_load_dwordx4 v[154:157], v10, s[36:39], 0 offen offset:2048 sc1
    s_waitcnt vmcnt(3)
    v_bitop3_b32 v188, v158, v159, s51 bitop3:0x7e
    v_bitop3_b32 v189, v160, v161, s51 bitop3:0x7e
    v_or_b32 v188, v188, v189
    v_cmp_ne_u32_sdwa vcc, v188, 0 src0_sel:BYTE_0 src1_sel:DWORD
    s_cbranch_vccz L_stok
L_poll_51:
    buffer_load_dwordx4 v[158:161], v11, s[36:39], 0 offen offset:0 sc1
    s_sub_u32 s55, s55, 1
    s_cbranch_scc1 L_bail
    s_waitcnt vmcnt(0)
    v_bitop3_b32 v188, v158, v159, s51 bitop3:0x7e
    v_bitop3_b32 v189, v160, v161, s51 bitop3:0x7e
    v_or_b32 v188, v188, v189
    v_cmp_ne_u32_sdwa vcc, v188, 0 src0_sel:BYTE_0 src1_sel:DWORD
    s_cbranch_vccnz L_poll_51
L_stok:
    v_add_f32 v170, v158, v160
    v_add_f32 v171, v159, v161
    s_nop 0
    v_add_f32_dpp v170, v170, v170 row_ror:8 row_mask:0xf bank_mask:0xf
    v_add_f32_dpp v171, v171, v171 row_ror:8 row_mask:0xf bank_mask:0xf
    s_nop 0
    v_add_f32_dpp v170, v170, v170 row_ror:4 row_mask:0xf bank_mask:0xf
    v_add_f32_dpp v171, v171, v171 row_ror:4 row_mask:0xf bank_mask:0xf
    s_nop 0
    v_add_f32_dpp v170, v170, v170 row_ror:2 row_mask:0xf bank_mask:0xf
    v_add_f32_dpp v171, v171, v171 row_ror:2 row_mask:0xf bank_mask:0xf
    s_nop 0
    v_add_f32_dpp v170, v170, v170 row_ror:1 row_mask:0xf bank_mask:0xf
    v_add_f32_dpp v171, v171, v171 row_ror:1 row_mask:0xf bank_mask:0xf
    v_mul_f32 v170, 0x3b000000, v170
    v_mul_f32 v171, 0x3b000000, v171
    v_fma_f32 v171, -v170, v170, v171
    v_max_f32 v171, 0, v171
    v_cvt_pk_bf16_f32 v172, v170, v171
    v_and_b32 v171, s60, v172
    v_lshlrev_b32 v147, 16, v172
    v_add_f32 v171, 0x3727c5ac, v171
    v_cvt_pk_bf16_f32 v171, v171, v171
    v_and_b32 v171, s60, v171
    v_sqrt_f32 v171, v171
    s_nop 0
    v_cvt_pk_bf16_f32 v171, v171, v171
    v_and_b32 v171, s60, v171
    v_rcp_f32 v148, v171
    s_nop 0
    v_mul_f32 v170, v147, v148
    v_mul_f32 v140, v140, v170
    v_mul_f32 v141, v141, v170
L_poll_53:
    buffer_load_dwordx4 v[150:153], v10, s[36:39], 0 offen sc1
    buffer_load_dwordx4 v[154:157], v10, s[36:39], 0 offen offset:2048 sc1
    s_sub_u32 s55, s55, 1
    s_cbranch_scc1 L_bail
    s_waitcnt vmcnt(2)
    v_bitop3_b32 v188, v150, v151, s51 bitop3:0x7e
    v_bitop3_b32 v189, v152, v153, s51 bitop3:0x7e
    v_bitop3_b32 v190, v154, v155, s51 bitop3:0x7e
    v_bitop3_b32 v191, v156, v157, s51 bitop3:0x7e
    v_add_f32 v162, v150, v154
    v_or3_b32 v188, v188, v189, v190
    v_add_f32 v164, v152, v156
    v_or_b32 v188, v188, v191
    v_add_f32 v163, v151, v155
    v_cmp_ne_u32_sdwa vcc, v188, 0 src0_sel:BYTE_0 src1_sel:DWORD
    v_add_f32 v165, v153, v157
    s_cbranch_vccnz L_poll_53
    s_branch L_aft
L_final:
    s_lshl_b32 s3, s49, 5
    v_add_lshl_u32 v162, s3, v7, 1
    s_mov_b32 exec_lo, 0xffff
    s_mov_b32 exec_hi, 0xffff
    buffer_store_short_d16_hi v146, v162, s[40:43], 0 offen
    s_mov_b64 exec, -1
    s_branch L_exit
L_last:
    s_lshl_b32 s3, s2, 2
    s_or_b32 s3, s3, s6
    s_cmp_lg_u32 s3, 1
    s_cbranch_scc1 L_exit
    s_add_u32 s3, s57, 2
    v_mov_b32 v162, s3
    v_mov_b32 v163, 0
    s_mov_b64 exec, 1
    buffer_store_dword v162, v163, s[36:39], 0 offen sc1
    s_mov_b64 exec, -1
L_exit:
L_bail:
L_end:
    s_endpgm
L_p1fail:
    s_mov_b64 exec, vcc
    buffer_load_dwordx4 v[150:153], v10, s[36:39], 0 offen sc1
    buffer_load_dwordx4 v[154:157], v10, s[36:39], 0 offen offset:2048 sc1
    s_barrier
    s_waitcnt vmcnt(0)
    v_bitop3_b32 v188, v150, v151, s51 bitop3:0x7e
    v_bitop3_b32 v189, v152, v153, s51 bitop3:0x7e
    v_bitop3_b32 v190, v154, v155, s51 bitop3:0x7e
    v_bitop3_b32 v191, v156, v157, s51 bitop3:0x7e
    v_add_f32 v162, v150, v154
    v_or3_b32 v188, v188, v189, v190
    v_add_f32 v164, v152, v156
    v_or_b32 v188, v188, v191
    v_add_f32 v163, v151, v155
    v_cmp_ne_u32_sdwa vcc, v188, 0 src0_sel:BYTE_0 src1_sel:DWORD
    v_add_f32 v165, v153, v157
    s_cbranch_vccz L_p1done
L_p1loop:
    s_mov_b64 exec, vcc
    buffer_load_dwordx4 v[150:153], v10, s[36:39], 0 offen sc1
    buffer_load_dwordx4 v[154:157], v10, s[36:39], 0 offen offset:2048 sc1
    s_sub_u32 s55, s55, 1
    s_cbranch_scc1 L_bail
    s_sleep 1
    s_waitcnt vmcnt(0)
    v_bitop3_b32 v188, v150, v151, s51 bitop3:0x7e
    v_bitop3_b32 v189, v152, v153, s51 bitop3:0x7e
    v_bitop3_b32 v190, v154, v155, s51 bitop3:0x7e
    v_bitop3_b32 v191, v156, v157, s51 bitop3:0x7e
    v_add_f32 v162, v150, v154
    v_or3_b32 v188, v188, v189, v190
    v_add_f32 v164, v152, v156
    v_or_b32 v188, v188, v191
    v_add_f32 v163, v151, v155
    v_cmp_ne_u32_sdwa vcc, v188, 0 src0_sel:BYTE_0 src1_sel:DWORD
    v_add_f32 v165, v153, v157
    s_cbranch_vccz L_p1done
    s_mov_b64 exec, vcc
    buffer_load_dwordx4 v[150:153], v10, s[36:39], 0 offen sc1
    buffer_load_dwordx4 v[154:157], v10, s[36:39], 0 offen offset:2048 sc1
    s_sub_u32 s55, s55, 1
    s_cbranch_scc1 L_bail
    s_sleep 1
    s_waitcnt vmcnt(0)
    v_bitop3_b32 v188, v150, v151, s51 bitop3:0x7e
    v_bitop3_b32 v189, v152, v153, s51 bitop3:0x7e
    v_bitop3_b32 v190, v154, v155, s51 bitop3:0x7e
    v_bitop3_b32 v191, v156, v157, s51 bitop3:0x7e
    v_add_f32 v162, v150, v154
    v_or3_b32 v188, v188, v189, v190
    v_add_f32 v164, v152, v156
    v_or_b32 v188, v188, v191
    v_add_f32 v163, v151, v155
    v_cmp_ne_u32_sdwa vcc, v188, 0 src0_sel:BYTE_0 src1_sel:DWORD
    v_add_f32 v165, v153, v157
    s_cbranch_vccz L_p1done
    s_mov_b64 exec, vcc
    buffer_load_dwordx4 v[150:153], v10, s[36:39], 0 offen sc1
    buffer_load_dwordx4 v[154:157], v10, s[36:39], 0 offen offset:2048 sc1
    s_sub_u32 s55, s55, 1
    s_cbranch_scc1 L_bail
    s_sleep 1
    s_waitcnt vmcnt(0)
    v_bitop3_b32 v188, v150, v151, s51 bitop3:0x7e
    v_bitop3_b32 v189, v152, v153, s51 bitop3:0x7e
    v_bitop3_b32 v190, v154, v155, s51 bitop3:0x7e
    v_bitop3_b32 v191, v156, v157, s51 bitop3:0x7e
    v_add_f32 v162, v150, v154
    v_or3_b32 v188, v188, v189, v190
    v_add_f32 v164, v152, v156
    v_or_b32 v188, v188, v191
    v_add_f32 v163, v151, v155
    v_cmp_ne_u32_sdwa vcc, v188, 0 src0_sel:BYTE_0 src1_sel:DWORD
    v_add_f32 v165, v153, v157
    s_cbranch_vccz L_p1done
    s_mov_b64 exec, vcc
    buffer_load_dwordx4 v[150:153], v10, s[36:39], s65 offen sc1
    buffer_load_dwordx4 v[154:157], v10, s[36:39], s65 offen offset:2048 sc1
    s_sub_u32 s55, s55, 1
    s_cbranch_scc1 L_bail
    s_sleep 1
    s_waitcnt vmcnt(0)
    v_bitop3_b32 v188, v150, v151, s51 bitop3:0x7e
    v_bitop3_b32 v189, v152, v153, s51 bitop3:0x7e
    v_bitop3_b32 v190, v154, v155, s51 bitop3:0x7e
    v_bitop3_b32 v191, v156, v157, s51 bitop3:0x7e
    v_add_f32 v162, v150, v154
    v_or3_b32 v188, v188, v189, v190
    v_add_f32 v164, v152, v156
    v_or_b32 v188, v188, v191
    v_add_f32 v163, v151, v155
    v_cmp_ne_u32_sdwa vcc, v188, 0 src0_sel:BYTE_0 src1_sel:DWORD
    v_add_f32 v165, v153, v157
    s_cbranch_vccz L_p1done
    s_branch L_p1loop
L_p1done:
    s_mov_b64 exec, -1
    s_branch L_p1ok
L_loader:
    v_lshlrev_b32 v179, 10, v3
    v_lshl_add_u32 v179, v2, 4, v179
    s_waitcnt lgkmcnt(0)
    s_load_dword s57, s[90:91], 0
    s_cmp_lg_u32 s2, 0
    s_cbranch_scc1 L_nowarm
    s_load_dword s60, s[90:91], 0xC000 glc
    s_load_dword s61, s[90:91], 0xE000 glc
L_nowarm:
    s_barrier
    s_add_u32 s36, s90, 0
    s_addc_u32 s37, s91, 0
    s_mov_b32 s38, 2097152
    s_mov_b32 s39, 0x20000
    s_cmp_lg_u32 s2, 0
    s_cbranch_scc1 L_noprobe
    s_mov_b32 s74, -1
    s_mov_b32 s75, -1
    s_waitcnt lgkmcnt(0)
    s_memtime s[62:63]
    s_waitcnt lgkmcnt(0)
    s_load_dword s60, s[90:91], 49152 glc
    s_waitcnt lgkmcnt(0)
    s_memtime s[64:65]
    s_waitcnt lgkmcnt(0)
    s_sub_u32 s62, s64, s62
    s_min_u32 s74, s74, s62
    s_waitcnt lgkmcnt(0)
    s_memtime s[62:63]
    s_waitcnt lgkmcnt(0)
    s_load_dword s60, s[90:91], 57344 glc
    s_waitcnt lgkmcnt(0)
    s_memtime s[64:65]
    s_waitcnt lgkmcnt(0)
    s_sub_u32 s62, s64, s62
    s_min_u32 s75, s75, s62
    s_waitcnt lgkmcnt(0)
    s_memtime s[62:63]
    s_waitcnt lgkmcnt(0)
    s_load_dword s60, s[90:91], 49152 glc
    s_waitcnt lgkmcnt(0)
    s_memtime s[64:65]
    s_waitcnt lgkmcnt(0)
    s_sub_u32 s62, s64, s62
    s_min_u32 s74, s74, s62
    s_waitcnt lgkmcnt(0)
    s_memtime s[62:63]
    s_waitcnt lgkmcnt(0)
    s_load_dword s60, s[90:91], 57344 glc
    s_waitcnt lgkmcnt(0)
    s_memtime s[64:65]
    s_waitcnt lgkmcnt(0)
    s_sub_u32 s62, s64, s62
    s_min_u32 s75, s75, s62
L_noprobe:
    s_cmp_lg_u32 s50, 0
    s_cbranch_scc1 L_ld1
    s_lshl_b32 s3, s4, 19
    s_lshl_b32 s92, s49, 15
    s_add_u32 s3, s3, s92
    s_add_u32 s24, s76, s3
    s_addc_u32 s25, s77, 0
    s_mov_b32 s26, 32768
    s_mov_b32 s27, 0x20000
    v_mov_b32 v171, -1
    s_mov_b32 s68, 524288
    s_lshl_b32 s3, s4, 16
    s_add_u32 s68, s68, s3
    s_lshl_b32 s3, s49, 12
    s_add_u32 s68, s68, s3
    v_lshl_add_u32 v172, v1, 7, s68
    v_subrev_u32 v173, 0, v1
    v_cmp_gt_u32 vcc, 32, v173
    s_nop 1
    v_cndmask_b32 v171, v171, v172, vcc
    s_mov_b32 s68, 1044480
    s_lshl_b32 s3, s50, 18
    s_add_u32 s68, s68, s3
    s_lshl_b32 s3, s4, 15
    s_add_u32 s68, s68, s3
    s_lshl_b32 s3, s49, 11
    s_add_u32 s68, s68, s3
    v_lshl_add_u32 v172, v1, 7, s68
    v_subrev_u32 v173, 32, v1
    v_cmp_gt_u32 vcc, 16, v173
    s_nop 1
    v_cndmask_b32 v171, v171, v172, vcc
    s_mov_b32 s68, 26624
    s_lshl_b32 s3, s4, 11
    s_add_u32 s68, s68, s3
    s_lshl_b32 s3, s7, 9
    s_add_u32 s68, s68, s3
    v_lshl_add_u32 v172, v1, 7, s68
    v_subrev_u32 v173, 48, v1
    v_cmp_gt_u32 vcc, 4, v173
    s_nop 1
    v_cndmask_b32 v171, v171, v172, vcc
    s_mov_b32 s68, 9728
    s_lshl_b32 s3, s4, 11
    s_add_u32 s68, s68, s3
    s_lshl_b32 s3, s7, 9
    s_add_u32 s68, s68, s3
    v_lshl_add_u32 v172, v1, 7, s68
    v_subrev_u32 v173, 52, v1
    v_cmp_gt_u32 vcc, 4, v173
    s_nop 1
    v_cndmask_b32 v171, v171, v172, vcc
    v_lshlrev_b32 v178, 5, v3
    v_xor_b32 v178, v178, v179
    s_barrier
    s_cmp_lg_u32 s2, 0
    s_cbranch_scc1 L_noprobe2
    s_waitcnt lgkmcnt(0)
    s_memtime s[62:63]
    s_waitcnt lgkmcnt(0)
    s_load_dword s60, s[90:91], 49152 glc
    s_waitcnt lgkmcnt(0)
    s_memtime s[64:65]
    s_waitcnt lgkmcnt(0)
    s_sub_u32 s62, s64, s62
    s_min_u32 s74, s74, s62
    s_waitcnt lgkmcnt(0)
    s_memtime s[62:63]
    s_waitcnt lgkmcnt(0)
    s_load_dword s60, s[90:91], 57344 glc
    s_waitcnt lgkmcnt(0)
    s_memtime s[64:65]
    s_waitcnt lgkmcnt(0)
    s_sub_u32 s62, s64, s62
    s_min_u32 s75, s75, s62
    s_getreg_b32 s60, hwreg(HW_REG_XCC_ID)
    s_bfe_u32 s60, s60, 0x10002
    s_cmp_gt_u32 s74, s75
    s_cselect_b32 s61, 1, 0
    s_xor_b32 s60, s60, s61
    s_lshl_b32 s60, s60, 8
    s_add_u32 s61, s57, 1
    s_and_b32 s61, s61, 0xff
    s_or_b32 s60, s60, s61
    v_mov_b32 v182, s60
    v_mov_b32 v183, s60
    v_mov_b32 v184, s60
    v_mov_b32 v185, s60
    v_mov_b32 v186, 12288
    s_mov_b64 exec, 1
    buffer_store_dwordx4 v[182:185], v186, s[36:39], 0 offen sc1
    s_mov_b64 exec, -1
L_noprobe2:
    s_barrier
    buffer_load_dword v149, v171, s[36:39], 0 offen
    s_add_u32 s70, s49, 0
    s_and_b32 s70, s70, 7
    s_lshl_b32 s71, s70, 10
    s_and_b32 s72, s70, 2
    s_lshl_b32 s72, s72, 6
    v_xor_b32 v180, s72, v178
    s_lshl_b32 s70, s70, 12
    s_add_u32 m0, s71, 49152
    s_add_u32 s92, s70, 0
    buffer_load_dwordx4 v180, s[24:27], s92 offen nt lds
    s_add_u32 m0, s71, 57344
    s_add_u32 s92, s70, 256
    buffer_load_dwordx4 v180, s[24:27], s92 offen nt lds
    s_add_u32 m0, s71, 65536
    s_add_u32 s92, s70, 512
    buffer_load_dwordx4 v180, s[24:27], s92 offen nt lds
    s_add_u32 m0, s71, 73728
    s_add_u32 s92, s70, 768
    buffer_load_dwordx4 v180, s[24:27], s92 offen nt lds
    s_barrier
    s_add_u32 s70, s49, 1
    s_and_b32 s70, s70, 7
    s_lshl_b32 s71, s70, 10
    s_and_b32 s72, s70, 2
    s_lshl_b32 s72, s72, 6
    v_xor_b32 v181, s72, v178
    s_lshl_b32 s70, s70, 12
    s_add_u32 m0, s71, 49152
    s_add_u32 s92, s70, 0
    buffer_load_dwordx4 v181, s[24:27], s92 offen nt lds
    s_add_u32 m0, s71, 57344
    s_add_u32 s92, s70, 256
    buffer_load_dwordx4 v181, s[24:27], s92 offen nt lds
    s_add_u32 m0, s71, 65536
    s_add_u32 s92, s70, 512
    buffer_load_dwordx4 v181, s[24:27], s92 offen nt lds
    s_add_u32 m0, s71, 73728
    s_add_u32 s92, s70, 768
    buffer_load_dwordx4 v181, s[24:27], s92 offen nt lds
    s_add_u32 s70, s49, 2
    s_and_b32 s70, s70, 7
    s_lshl_b32 s71, s70, 10
    s_and_b32 s72, s70, 2
    s_lshl_b32 s72, s72, 6
    v_xor_b32 v180, s72, v178
    s_lshl_b32 s70, s70, 12
    s_add_u32 m0, s71, 49152
    s_add_u32 s92, s70, 0
    buffer_load_dwordx4 v180, s[24:27], s92 offen nt lds
    s_add_u32 m0, s71, 57344
    s_add_u32 s92, s70, 256
    buffer_load_dwordx4 v180, s[24:27], s92 offen nt lds
    s_add_u32 m0, s71, 65536
    s_add_u32 s92, s70, 512
    buffer_load_dwordx4 v180, s[24:27], s92 offen nt lds
    s_add_u32 m0, s71, 73728
    s_add_u32 s92, s70, 768
    buffer_load_dwordx4 v180, s[24:27], s92 offen nt lds
    s_add_u32 s70, s49, 3
    s_and_b32 s70, s70, 7
    s_lshl_b32 s71, s70, 10
    s_and_b32 s72, s70, 2
    s_lshl_b32 s72, s72, 6
    v_xor_b32 v181, s72, v178
    s_lshl_b32 s70, s70, 12
    s_add_u32 m0, s71, 49152
    s_add_u32 s92, s70, 0
    buffer_load_dwordx4 v181, s[24:27], s92 offen nt lds
    s_add_u32 m0, s71, 57344
    s_add_u32 s92, s70, 256
    buffer_load_dwordx4 v181, s[24:27], s92 offen nt lds
    s_add_u32 m0, s71, 65536
    s_add_u32 s92, s70, 512
    buffer_load_dwordx4 v181, s[24:27], s92 offen nt lds
    s_add_u32 m0, s71, 73728
    s_add_u32 s92, s70, 768
    buffer_load_dwordx4 v181, s[24:27], s92 offen nt lds
    s_add_u32 s70, s49, 4
    s_and_b32 s70, s70, 7
    s_lshl_b32 s71, s70, 10
    s_and_b32 s72, s70, 2
    s_lshl_b32 s72, s72, 6
    v_xor_b32 v180, s72, v178
    s_lshl_b32 s70, s70, 12
    s_add_u32 m0, s71, 49152
    s_add_u32 s92, s70, 0
    buffer_load_dwordx4 v180, s[24:27], s92 offen nt lds
    s_add_u32 m0, s71, 57344
    s_add_u32 s92, s70, 256
    buffer_load_dwordx4 v180, s[24:27], s92 offen nt lds
    s_add_u32 m0, s71, 65536
    s_add_u32 s92, s70, 512
    buffer_load_dwordx4 v180, s[24:27], s92 offen nt lds
    s_add_u32 m0, s71, 73728
    s_add_u32 s92, s70, 768
    buffer_load_dwordx4 v180, s[24:27], s92 offen nt lds
    s_add_u32 s70, s49, 5
    s_and_b32 s70, s70, 7
    s_lshl_b32 s71, s70, 10
    s_and_b32 s72, s70, 2
    s_lshl_b32 s72, s72, 6
    v_xor_b32 v181, s72, v178
    s_lshl_b32 s70, s70, 12
    s_add_u32 m0, s71, 49152
    s_add_u32 s92, s70, 0
    buffer_load_dwordx4 v181, s[24:27], s92 offen nt lds
    s_add_u32 m0, s71, 57344
    s_add_u32 s92, s70, 256
    buffer_load_dwordx4 v181, s[24:27], s92 offen nt lds
    s_add_u32 m0, s71, 65536
    s_add_u32 s92, s70, 512
    buffer_load_dwordx4 v181, s[24:27], s92 offen nt lds
    s_add_u32 m0, s71, 73728
    s_add_u32 s92, s70, 768
    buffer_load_dwordx4 v181, s[24:27], s92 offen nt lds
    s_add_u32 s70, s49, 6
    s_and_b32 s70, s70, 7
    s_lshl_b32 s71, s70, 10
    s_and_b32 s72, s70, 2
    s_lshl_b32 s72, s72, 6
    v_xor_b32 v180, s72, v178
    s_lshl_b32 s70, s70, 12
    s_add_u32 m0, s71, 49152
    s_add_u32 s92, s70, 0
    buffer_load_dwordx4 v180, s[24:27], s92 offen nt lds
    s_add_u32 m0, s71, 57344
    s_add_u32 s92, s70, 256
    buffer_load_dwordx4 v180, s[24:27], s92 offen nt lds
    s_add_u32 m0, s71, 65536
    s_add_u32 s92, s70, 512
    buffer_load_dwordx4 v180, s[24:27], s92 offen nt lds
    s_add_u32 m0, s71, 73728
    s_add_u32 s92, s70, 768
    buffer_load_dwordx4 v180, s[24:27], s92 offen nt lds
    s_add_u32 s70, s49, 7
    s_and_b32 s70, s70, 7
    s_lshl_b32 s71, s70, 10
    s_and_b32 s72, s70, 2
    s_lshl_b32 s72, s72, 6
    v_xor_b32 v181, s72, v178
    s_lshl_b32 s70, s70, 12
    s_add_u32 m0, s71, 49152
    s_add_u32 s92, s70, 0
    buffer_load_dwordx4 v181, s[24:27], s92 offen nt lds
    s_add_u32 m0, s71, 57344
    s_add_u32 s92, s70, 256
    buffer_load_dwordx4 v181, s[24:27], s92 offen nt lds
    s_add_u32 m0, s71, 65536
    s_add_u32 s92, s70, 512
    buffer_load_dwordx4 v181, s[24:27], s92 offen nt lds
    s_barrier
    s_add_u32 m0, s71, 73728
    s_add_u32 s92, s70, 768
    buffer_load_dwordx4 v181, s[24:27], s92 offen nt lds
    s_branch L_ld2
L_ld1:
    s_mul_i32 s3, s49, 114688
    s_mul_i32 s92, s4, 448
    s_add_u32 s3, s3, s92
    s_add_u32 s24, s80, s3
    s_addc_u32 s25, s81, 0
    s_mov_b32 s26, 111552
    s_mov_b32 s27, 0x20000
    s_mul_i32 s92, s4, 14
    s_add_u32 s92, s92, s49
    s_lshl_b32 s3, s92, 14
    s_add_u32 s28, s84, s3
    s_addc_u32 s29, s85, 0
    s_mov_b32 s30, 16384
    s_mov_b32 s31, 0x20000
    s_cmp_lt_u32 s49, 14
    s_cselect_b32 s30, 16384, 0
    s_movk_i32 s3, 3584
    v_add_u32 v180, 0, v1
    v_mul_u32_u24 v181, 2341, v180
    v_lshrrev_b32 v181, 16, v181
    v_mul_u32_u24 v182, 28, v181
    v_sub_u32 v182, v180, v182
    v_lshlrev_b32 v182, 4, v182
    v_mad_u32_u24 v72, v181, s3, v182
    v_add_u32 v180, 64, v1
    v_mul_u32_u24 v181, 2341, v180
    v_lshrrev_b32 v181, 16, v181
    v_mul_u32_u24 v182, 28, v181
    v_sub_u32 v182, v180, v182
    v_lshlrev_b32 v182, 4, v182
    v_mad_u32_u24 v73, v181, s3, v182
    v_add_u32 v180, 128, v1
    v_mul_u32_u24 v181, 2341, v180
    v_lshrrev_b32 v181, 16, v181
    v_mul_u32_u24 v182, 28, v181
    v_sub_u32 v182, v180, v182
    v_lshlrev_b32 v182, 4, v182
    v_mad_u32_u24 v74, v181, s3, v182
    v_add_u32 v180, 192, v1
    v_mul_u32_u24 v181, 2341, v180
    v_lshrrev_b32 v181, 16, v181
    v_mul_u32_u24 v182, 28, v181
    v_sub_u32 v182, v180, v182
    v_lshlrev_b32 v182, 4, v182
    v_mad_u32_u24 v75, v181, s3, v182
    v_add_u32 v180, 256, v1
    v_mul_u32_u24 v181, 2341, v180
    v_lshrrev_b32 v181, 16, v181
    v_mul_u32_u24 v182, 28, v181
    v_sub_u32 v182, v180, v182
    v_lshlrev_b32 v182, 4, v182
    v_mad_u32_u24 v76, v181, s3, v182
    v_add_u32 v180, 320, v1
    v_mul_u32_u24 v181, 2341, v180
    v_lshrrev_b32 v181, 16, v181
    v_mul_u32_u24 v182, 28, v181
    v_sub_u32 v182, v180, v182
    v_lshlrev_b32 v182, 4, v182
    v_mad_u32_u24 v77, v181, s3, v182
    v_add_u32 v180, 384, v1
    v_mul_u32_u24 v181, 2341, v180
    v_lshrrev_b32 v181, 16, v181
    v_mul_u32_u24 v182, 28, v181
    v_sub_u32 v182, v180, v182
    v_lshlrev_b32 v182, 4, v182
    v_mad_u32_u24 v78, v181, s3, v182
    v_add_u32 v180, 448, v1
    v_mul_u32_u24 v181, 2341, v180
    v_lshrrev_b32 v181, 16, v181
    v_mul_u32_u24 v182, 28, v181
    v_sub_u32 v182, v180, v182
    v_lshlrev_b32 v182, 4, v182
    v_mad_u32_u24 v79, v181, s3, v182
    v_add_u32 v180, 512, v1
    v_mul_u32_u24 v181, 2341, v180
    v_lshrrev_b32 v181, 16, v181
    v_mul_u32_u24 v182, 28, v181
    v_sub_u32 v182, v180, v182
    v_lshlrev_b32 v182, 4, v182
    v_mad_u32_u24 v80, v181, s3, v182
    v_add_u32 v180, 576, v1
    v_mul_u32_u24 v181, 2341, v180
    v_lshrrev_b32 v181, 16, v181
    v_mul_u32_u24 v182, 28, v181
    v_sub_u32 v182, v180, v182
    v_lshlrev_b32 v182, 4, v182
    v_mad_u32_u24 v81, v181, s3, v182
    v_add_u32 v180, 640, v1
    v_mul_u32_u24 v181, 2341, v180
    v_lshrrev_b32 v181, 16, v181
    v_mul_u32_u24 v182, 28, v181
    v_sub_u32 v182, v180, v182
    v_lshlrev_b32 v182, 4, v182
    v_mad_u32_u24 v82, v181, s3, v182
    v_add_u32 v180, 704, v1
    v_mul_u32_u24 v181, 2341, v180
    v_lshrrev_b32 v181, 16, v181
    v_mul_u32_u24 v182, 28, v181
    v_sub_u32 v182, v180, v182
    v_lshlrev_b32 v182, 4, v182
    v_mad_u32_u24 v83, v181, s3, v182
    v_add_u32 v180, 768, v1
    v_mul_u32_u24 v181, 2341, v180
    v_lshrrev_b32 v181, 16, v181
    v_mul_u32_u24 v182, 28, v181
    v_sub_u32 v182, v180, v182
    v_lshlrev_b32 v182, 4, v182
    v_mad_u32_u24 v84, v181, s3, v182
    v_add_u32 v180, 832, v1
    v_mul_u32_u24 v181, 2341, v180
    v_lshrrev_b32 v181, 16, v181
    v_mul_u32_u24 v182, 28, v181
    v_sub_u32 v182, v180, v182
    v_lshlrev_b32 v182, 4, v182
    v_mad_u32_u24 v85, v181, s3, v182
    v_add_u32 v180, 896, v1
    v_mul_u32_u24 v181, 2341, v180
    v_lshrrev_b32 v181, 16, v181
    v_mul_u32_u24 v182, 28, v181
    v_sub_u32 v182, v180, v182
    v_lshlrev_b32 v182, 4, v182
    v_mad_u32_u24 v86, v181, s3, v182
    v_mov_b32 v171, -1
    s_mov_b32 s68, 262144
    s_lshl_b32 s3, s4, 14
    s_add_u32 s68, s68, s3
    s_lshl_b32 s3, s49, 10
    s_add_u32 s68, s68, s3
    v_lshl_add_u32 v172, v1, 7, s68
    v_subrev_u32 v173, 0, v1
    v_cmp_gt_u32 vcc, 8, v173
    s_nop 1
    v_cndmask_b32 v171, v171, v172, vcc
    s_mov_b32 s68, 1047552
    s_lshl_b32 s3, s50, 18
    s_add_u32 s68, s68, s3
    s_lshl_b32 s3, s4, 15
    s_add_u32 s68, s68, s3
    s_lshl_b32 s3, s49, 11
    s_add_u32 s68, s68, s3
    v_lshl_add_u32 v172, v1, 7, s68
    v_subrev_u32 v173, 8, v1
    v_cmp_gt_u32 vcc, 16, v173
    s_nop 1
    v_cndmask_b32 v171, v171, v172, vcc
    s_mov_b32 s68, 7168
    s_lshl_b32 s3, s4, 8
    s_add_u32 s68, s68, s3
    v_lshl_add_u32 v172, v1, 7, s68
    v_subrev_u32 v173, 24, v1
    v_cmp_gt_u32 vcc, 2, v173
    s_nop 1
    v_cndmask_b32 v171, v171, v172, vcc
    s_mov_b32 s68, 13056
    s_lshl_b32 s3, s4, 11
    s_add_u32 s68, s68, s3
    s_lshl_b32 s3, s7, 9
    s_add_u32 s68, s68, s3
    v_lshl_add_u32 v172, v1, 7, s68
    v_subrev_u32 v173, 26, v1
    v_cmp_gt_u32 vcc, 4, v173
    s_nop 1
    v_cndmask_b32 v171, v171, v172, vcc
    s_barrier
    s_barrier
    buffer_load_dword v149, v171, s[36:39], 0 offen
    s_mov_b32 m0, 49152
    s_nop 0
    buffer_load_dwordx4 v72, s[24:27], 0 offen nt lds
    s_mov_b32 m0, 50176
    s_nop 0
    buffer_load_dwordx4 v73, s[24:27], 0 offen nt lds
    s_mov_b32 m0, 51200
    s_nop 0
    buffer_load_dwordx4 v74, s[24:27], 0 offen nt lds
    s_mov_b32 m0, 52224
    s_nop 0
    buffer_load_dwordx4 v75, s[24:27], 0 offen nt lds
    s_barrier
    s_mov_b32 m0, 53248
    s_nop 0
    buffer_load_dwordx4 v76, s[24:27], 0 offen nt lds
    s_mov_b32 m0, 54272
    s_nop 0
    buffer_load_dwordx4 v77, s[24:27], 0 offen nt lds
    s_mov_b32 m0, 55296
    s_nop 0
    buffer_load_dwordx4 v78, s[24:27], 0 offen nt lds
    s_mov_b32 m0, 56320
    s_nop 0
    buffer_load_dwordx4 v79, s[24:27], 0 offen nt lds
    s_mov_b32 m0, 57344
    s_nop 0
    buffer_load_dwordx4 v80, s[24:27], 0 offen nt lds
    s_mov_b32 m0, 58368
    s_nop 0
    buffer_load_dwordx4 v81, s[24:27], 0 offen nt lds
    s_mov_b32 m0, 59392
    s_nop 0
    buffer_load_dwordx4 v82, s[24:27], 0 offen nt lds
    s_mov_b32 m0, 60416
    s_nop 0
    buffer_load_dwordx4 v83, s[24:27], 0 offen nt lds
    s_mov_b32 m0, 61440
    s_nop 0
    buffer_load_dwordx4 v84, s[24:27], 0 offen nt lds
    s_mov_b32 m0, 62464
    s_nop 0
    buffer_load_dwordx4 v85, s[24:27], 0 offen nt lds
    s_mov_b32 m0, 63488
    s_nop 0
    buffer_load_dwordx4 v86, s[24:27], 0 offen nt lds
    s_add_u32 s70, s49, 0
    s_and_b32 s70, s70, 3
    s_lshl_b32 s71, s70, 10
    s_lshl_b32 s70, s70, 12
    s_add_u32 m0, s71, 65536
    s_add_u32 s92, s70, 0
    buffer_load_dwordx4 v179, s[28:31], s92 offen nt lds
    s_add_u32 m0, s71, 69632
    s_add_u32 s92, s70, 256
    buffer_load_dwordx4 v179, s[28:31], s92 offen nt lds
    s_add_u32 m0, s71, 73728
    s_add_u32 s92, s70, 512
    buffer_load_dwordx4 v179, s[28:31], s92 offen nt lds
    s_add_u32 m0, s71, 77824
    s_add_u32 s92, s70, 768
    buffer_load_dwordx4 v179, s[28:31], s92 offen nt lds
    s_add_u32 s70, s49, 1
    s_and_b32 s70, s70, 3
    s_lshl_b32 s71, s70, 10
    s_lshl_b32 s70, s70, 12
    s_add_u32 m0, s71, 65536
    s_add_u32 s92, s70, 0
    buffer_load_dwordx4 v179, s[28:31], s92 offen nt lds
    s_add_u32 m0, s71, 69632
    s_add_u32 s92, s70, 256
    buffer_load_dwordx4 v179, s[28:31], s92 offen nt lds
    s_add_u32 m0, s71, 73728
    s_add_u32 s92, s70, 512
    buffer_load_dwordx4 v179, s[28:31], s92 offen nt lds
    s_add_u32 m0, s71, 77824
    s_add_u32 s92, s70, 768
    buffer_load_dwordx4 v179, s[28:31], s92 offen nt lds
    s_add_u32 s70, s49, 2
    s_and_b32 s70, s70, 3
    s_lshl_b32 s71, s70, 10
    s_lshl_b32 s70, s70, 12
    s_add_u32 m0, s71, 65536
    s_add_u32 s92, s70, 0
    buffer_load_dwordx4 v179, s[28:31], s92 offen nt lds
    s_add_u32 m0, s71, 69632
    s_add_u32 s92, s70, 256
    buffer_load_dwordx4 v179, s[28:31], s92 offen nt lds
    s_add_u32 m0, s71, 73728
    s_add_u32 s92, s70, 512
    buffer_load_dwordx4 v179, s[28:31], s92 offen nt lds
    s_add_u32 m0, s71, 77824
    s_add_u32 s92, s70, 768
    buffer_load_dwordx4 v179, s[28:31], s92 offen nt lds
    s_add_u32 s70, s49, 3
    s_and_b32 s70, s70, 3
    s_lshl_b32 s71, s70, 10
    s_lshl_b32 s70, s70, 12
    s_add_u32 m0, s71, 65536
    s_add_u32 s92, s70, 0
    buffer_load_dwordx4 v179, s[28:31], s92 offen nt lds
    s_add_u32 m0, s71, 69632
    s_add_u32 s92, s70, 256
    buffer_load_dwordx4 v179, s[28:31], s92 offen nt lds
    s_add_u32 m0, s71, 73728
    s_add_u32 s92, s70, 512
    buffer_load_dwordx4 v179, s[28:31], s92 offen nt lds
    s_barrier
    s_add_u32 m0, s71, 77824
    s_add_u32 s92, s70, 768
    buffer_load_dwordx4 v179, s[28:31], s92 offen nt lds
L_ld2:
    s_waitcnt vmcnt(0)
    s_barrier
    s_endpgm
L_slow_3:
    buffer_store_dwordx2 v[182:183], v19, s[36:39], 0 offen sc1
    s_nop 1
    s_branch L_back_4
L_slow_5:
    buffer_store_dwordx4 v[178:181], v20, s[36:39], 0 offen sc1
    s_nop 1
    s_branch L_back_6
L_retry_8:
    s_mov_b64 exec, vcc
    s_sub_u32 s55, s55, 1
    s_cbranch_scc1 L_bail
    s_branch L_poll_7
L_omax:
    v_max_f32_dpp v170, v154, v154 row_ror:8 row_mask:0xf bank_mask:0xf
    s_nop 1
    v_max_f32_dpp v170, v170, v170 row_ror:4 row_mask:0xf bank_mask:0xf
    s_nop 1
    v_max_f32_dpp v170, v170, v170 row_ror:2 row_mask:0xf bank_mask:0xf
    v_mov_b32 v171, v170
    s_nop 1
    v_permlane16_swap_b32 v171, v170
    v_max_f32 v170, v170, v171
    v_mov_b32 v171, v170
    s_nop 1
    v_permlane32_swap_b32 v171, v170
    v_max_f32 v170, v170, v171
    v_sub_f32 v170, v154, v170
    v_exp_f32 v170, v170
    s_nop 0
    s_branch L_omaxback
L_slow_9:
    buffer_store_dwordx2 v[166:167], v21, s[36:39], 0 offen sc1
    s_nop 1
    s_branch L_back_10
L_slow_19:
    buffer_store_dword v170, v32, s[36:39], s64 offen sc1
    s_nop 1
    s_branch L_back_20
L_slow_27:
    buffer_store_dword v182, v28, s[36:39], 0 offen offset:2048 sc1
    s_nop 1
    s_branch L_back_28
L_slow_29:
    buffer_store_dword v170, v32, s[36:39], 0 offen sc1
    s_nop 1
    s_branch L_back_30
L_slow_35:
    buffer_store_dwordx2 v[174:175], v21, s[36:39], 0 offen sc1
    s_nop 1
    s_branch L_back_36
L_slow_41:
    buffer_store_dword v166, v30, s[36:39], 0 offen sc1
    s_nop 1
    s_branch L_back_42
L_slow_43:
    buffer_store_dword v178, v28, s[36:39], 0 offen offset:0 sc1
    s_nop 1
    s_branch L_back_44
L_slow_49:
    buffer_store_dword v166, v9, s[36:39], 0 offen sc1
    s_nop 1
    s_branch L_back_50
L_codeend:
.if L_codeend-L_start > 20480
.error "code larger than the prefetched range"
.endif
.section .rodata,"a"
.p2align 6
.amdhsa_kernel interleave_layers__sliding_block_cached__dense_activation_mish__decode_kernel
  .amdhsa_next_free_vgpr 256
  .amdhsa_next_free_sgpr 102
  .amdhsa_accum_offset 192
  .amdhsa_group_segment_fixed_size 0
  .amdhsa_kernarg_size 96
  .amdhsa_user_sgpr_count 2
  .amdhsa_user_sgpr_kernarg_segment_ptr 1
  .amdhsa_system_sgpr_workgroup_id_x 1
.end_amdhsa_kernel
```
